```python
import torch

def _softmax(x, axis=-1):
    return torch.softmax(x, dim=axis)
def _gelu(x):
    return torch.nn.functional.gelu(x, approximate="tanh")
def _silu(x):
    return torch.nn.functional.silu(x)
def _sigmoid(x):
    return torch.sigmoid(x)
def _layernorm(x, axis=-1, eps=1e-5):
    m = x.mean(dim=axis, keepdim=True)
    v = x.var(dim=axis, keepdim=True, unbiased=False)
    return (x - m) / torch.sqrt(v + eps)
def _scatter_add(tgt, idx, src, axis=0):
    return tgt.clone().index_add_(axis, idx, src)
def _segment_sum(src, seg, n):
    out = torch.zeros((n,) + src.shape[1:], dtype=src.dtype)
    return out.index_add_(0, seg, src)
def _pad(x, pw):
    flat = tuple(v for pair in reversed(pw) for v in pair)
    return torch.nn.functional.pad(x, flat)

kernel_name = 'gated_mix__grouped_kv_mqa__mha_block__prompt'

def setup_inputs():

    _w = (lambda a: (lambda t: t.to(torch.bfloat16) if t.is_floating_point() else t)(torch.as_tensor(a)))
    def _A_setup():
        B, S, D, H = 1, 2048, 512, 32
        Dh = D // H
        return {
            "x": _w((lambda *s: torch.randn(*s, dtype=torch.bfloat16) * 0.05)(B, S, D)),
            "wq": _w((lambda *s: torch.randn(*s, dtype=torch.bfloat16) * 1.6)(D, H * Dh)),
            "wk": _w((lambda *s: torch.randn(*s, dtype=torch.bfloat16) * 1.6)(D, Dh)),
            "wv": _w((lambda *s: torch.randn(*s, dtype=torch.bfloat16) * 0.8)(D, Dh)),
            "wo": _w((lambda *s: torch.randn(*s, dtype=torch.bfloat16) * 0.8)(H * Dh, D)),
        }
    _A_in = _A_setup()

    def _B_setup():
        B, S, D, H = 1, 2048, 512, 32
        return {
            "x": _w((lambda *s: torch.randn(*s, dtype=torch.bfloat16) * 0.05)(B, S, D)),
            "wqkv": _w((lambda *s: torch.randn(*s, dtype=torch.bfloat16) * 3.2)(D, 3 * D)),
            "wo": _w((lambda *s: torch.randn(*s, dtype=torch.bfloat16) * 0.05)(D, D)),
        }
    _B_in = _B_setup()

    return {
        "A_x": _A_in["x"],
        "A_wq": _A_in["wq"],
        "A_wk": _A_in["wk"],
        "A_wv": _A_in["wv"],
        "A_wo": _A_in["wo"],
        "B_x": _B_in["x"],
        "B_wqkv": _B_in["wqkv"],
        "B_wo": _B_in["wo"],
        "gate_w": _w((lambda *s: torch.randn(*s, dtype=torch.bfloat16) * 0.1)(512) * 16.0),
    }

def reference(A_x, A_wq, A_wk, A_wv, A_wo, B_x, B_wqkv, B_wo, gate_w):
    def _A_ref(x, wq, wk, wv, wo):
        B, S, D = x.shape
        H = 32
        Dh = D // H
        q = (lambda x, *d: x.permute(*d))((x @ wq).reshape(B, S, H, Dh), 0, 2, 1, 3)
        k = x @ wk
        v = x @ wv
        scores = torch.einsum("bhqd,bkd->bhqk", q, k) * (Dh ** -0.5)
        p = _softmax(scores, axis=-1)
        o = torch.einsum("bhqk,bkd->bhqd", p, v)
        return (lambda x, *d: x.permute(*d))(o, 0, 2, 1, 3).reshape(B, S, H * Dh) @ wo

    def _B_ref(x, wqkv, wo):
        B, S, D = x.shape
        H = 32
        Dh = D // H
        qkv = (lambda x, *d: x.permute(*d))((x @ wqkv).reshape(B, S, 3, H, Dh), 2, 0, 3, 1, 4)
        q, k, v = qkv[0], qkv[1], qkv[2]
        scores = torch.einsum("bhqd,bhkd->bhqk", q, k) * (Dh ** -0.5)
        p = _softmax(scores, axis=-1)
        o = torch.einsum("bhqk,bhkd->bhqd", p, v)
        return (lambda x, *d: x.permute(*d))(o, 0, 2, 1, 3).reshape(B, S, D) @ wo

    x = A_x
    g = _sigmoid((x * gate_w).sum(-1, keepdims=True))
    a = _A_ref(x, A_wq, A_wk, A_wv, A_wo)
    b = _B_ref(x, B_wqkv, B_wo)
    return g * a + (1 - g) * b
```

```asm
; @launch kernel=proj_kernel grid=(256,1,1) block=(320,1,1) lds=147456
; @launch kernel=attn_kernel grid=(256,1,1) block=(1024,1,1) lds=140288
; @launch kernel=out_kernel grid=(256,1,1) block=(512,1,1) lds=131072
.amdgcn_target "amdgcn-amd-amdhsa--gfx950"
.text
.globl proj_kernel
.p2align 8
.type proj_kernel,@function
proj_kernel:
    s_cmp_ge_u32 s2, 256
    s_cbranch_scc1 L_proj_end
    s_load_dwordx8 s[4:11], s[0:1], 0
    s_load_dwordx2 s[12:13], s[0:1], 48
    s_load_dwordx2 s[14:15], s[0:1], 88
    s_load_dwordx2 s[50:51], s[0:1], 64
    v_and_b32 v1, 63, v0
    v_lshrrev_b32 v21, 6, v0
    v_lshlrev_b32 v2, 4, v1
    s_and_b32 s38, s2, 1
    s_lshl_b32 s38, s38, 3
    s_lshr_b32 s39, s2, 3
    s_and_b32 s40, s39, 7
    s_add_u32 s32, s38, s40
    s_and_b32 s38, s2, 6
    s_lshl_b32 s38, s38, 1
    s_lshr_b32 s39, s39, 3
    s_add_u32 s33, s38, s39
    v_readfirstlane_b32 s34, v21
    v_and_b32 v21, 31, v1
    v_and_b32 v22, 15, v1
    v_lshrrev_b32 v23, 5, v1
    v_xor_b32 v22, v22, v23
    v_lshlrev_b32 v22, 4, v22
    v_lshlrev_b32 v21, 10, v21
    v_add_u32 v5, v21, v22
    v_xor_b32 v6, 32, v5
    v_xor_b32 v7, 64, v5
    v_xor_b32 v8, 96, v5
    v_xor_b32 v9, 128, v5
    v_xor_b32 v10, 160, v5
    v_xor_b32 v11, 192, v5
    v_xor_b32 v12, 224, v5
    v_add_u32 v13, 0x10000, v5
    v_add_u32 v14, 0x10000, v6
    v_add_u32 v15, 0x10000, v7
    v_add_u32 v16, 0x10000, v8
    v_add_u32 v17, 0x10000, v9
    v_add_u32 v18, 0x10000, v10
    v_add_u32 v19, 0x10000, v11
    v_add_u32 v20, 0x10000, v12
    s_cmp_eq_u32 s34, 4
    s_cbranch_scc1 L_proj_special
    s_lshl_b32 s38, s32, 7
    s_lshl_b32 s39, s34, 3
    s_add_u32 s38, s38, s39
    s_lshl_b32 s35, s38, 10
    s_lshl_b32 s42, s34, 12
    s_lshl_b32 s43, s34, 13
    s_waitcnt lgkmcnt(0)
    s_mov_b32 s16, s4
    s_and_b32 s17, s5, 0xffff
    s_mov_b32 s18, 2097152
    s_mov_b32 s19, 0x00020000
    s_cmp_lt_u32 s33, 4
    s_cselect_b32 s20, s6, s12
    s_cselect_b32 s39, s7, s13
    s_cselect_b32 s37, 1, 3
    s_cselect_b32 s38, 0, 4
    s_and_b32 s21, s39, 0xffff
    s_lshl_b32 s22, s37, 19
    s_mov_b32 s23, 0x00020000
    s_lshl_b32 s37, s37, 10
    s_sub_u32 s38, s33, s38
    s_lshl_b32 s38, s38, 8
    s_lshl_b32 s44, s37, 2
    s_lshl_b32 s45, s37, 6
    s_lshl_b32 s39, s34, 4
    s_mul_i32 s39, s39, s37
    s_add_u32 s36, s38, s39
    v_lshrrev_b32 v21, 4, v1
    v_mul_lo_u32 v22, v21, s37
    v_lshlrev_b32 v21, 2, v21
    v_and_b32 v23, 15, v1
    v_xor_b32 v21, v21, v23
    v_lshlrev_b32 v21, 4, v21
    v_add_u32 v3, v21, v22
    s_and_b32 s38, s34, 1
    s_lshl_b32 s38, s38, 7
    v_xor_b32 v24, s38, v2
    s_mov_b32 s28, s50
    s_and_b32 s29, s51, 0xffff
    s_mov_b32 s30, 1024
    s_mov_b32 s31, 0x00020000
    s_lshl_b32 s38, s32, 7
    s_lshl_b32 s39, s33, 3
    s_add_u32 s38, s38, s39
    s_lshl_b32 s39, s34, 1
    s_add_u32 s41, s38, s39
    s_lshl_b32 s38, s41, 10
    buffer_load_dwordx4 v[52:55], v2, s[16:19], s38 offen
    buffer_load_dwordx4 v[56:59], v2, s[16:19], s38 offen offset:1024
    buffer_load_dwordx4 v[60:63], v2, s[28:31], 0 offen
    s_mul_i32 s39, s45, 0
    s_add_u32 s39, s39, s36
    s_add_u32 m0, s42, 0
    s_nop 0
    buffer_load_dwordx4 v3, s[20:23], s39 offen lds
    s_add_u32 s39, s39, s44
    s_add_u32 m0, s42, 1024
    s_nop 0
    buffer_load_dwordx4 v3, s[20:23], s39 offen lds
    s_add_u32 s39, s39, s44
    s_add_u32 m0, s42, 2048
    s_nop 0
    buffer_load_dwordx4 v3, s[20:23], s39 offen lds
    s_add_u32 s39, s39, s44
    s_add_u32 m0, s42, 3072
    s_nop 0
    buffer_load_dwordx4 v3, s[20:23], s39 offen lds
    v_xor_b32 v44, 0, v24
    v_xor_b32 v45, 16, v24
    v_xor_b32 v46, 32, v24
    v_xor_b32 v47, 48, v24
    v_xor_b32 v48, 64, v24
    v_xor_b32 v49, 80, v24
    v_xor_b32 v50, 96, v24
    v_xor_b32 v51, 112, v24
    s_add_u32 m0, s43, 65536
    s_add_u32 s38, s35, 0
    buffer_load_dwordx4 v44, s[16:19], s38 offen lds
    s_add_u32 m0, s43, 66560
    s_add_u32 s38, s35, 1024
    buffer_load_dwordx4 v45, s[16:19], s38 offen lds
    s_add_u32 m0, s43, 67584
    s_add_u32 s38, s35, 2048
    buffer_load_dwordx4 v46, s[16:19], s38 offen lds
    s_add_u32 m0, s43, 68608
    s_add_u32 s38, s35, 3072
    buffer_load_dwordx4 v47, s[16:19], s38 offen lds
    s_add_u32 m0, s43, 69632
    s_add_u32 s38, s35, 4096
    buffer_load_dwordx4 v48, s[16:19], s38 offen lds
    s_add_u32 m0, s43, 70656
    s_add_u32 s38, s35, 5120
    buffer_load_dwordx4 v49, s[16:19], s38 offen lds
    s_add_u32 m0, s43, 71680
    s_add_u32 s38, s35, 6144
    buffer_load_dwordx4 v50, s[16:19], s38 offen lds
    s_add_u32 m0, s43, 72704
    s_add_u32 s38, s35, 7168
    buffer_load_dwordx4 v51, s[16:19], s38 offen lds
    s_mul_i32 s39, s45, 1
    s_add_u32 s39, s39, s36
    s_add_u32 m0, s42, 16384
    s_nop 0
    buffer_load_dwordx4 v3, s[20:23], s39 offen lds
    s_add_u32 s39, s39, s44
    s_add_u32 m0, s42, 17408
    s_nop 0
    buffer_load_dwordx4 v3, s[20:23], s39 offen lds
    s_add_u32 s39, s39, s44
    s_add_u32 m0, s42, 18432
    s_nop 0
    buffer_load_dwordx4 v3, s[20:23], s39 offen lds
    s_add_u32 s39, s39, s44
    s_add_u32 m0, s42, 19456
    s_nop 0
    buffer_load_dwordx4 v3, s[20:23], s39 offen lds
    s_mul_i32 s39, s45, 2
    s_add_u32 s39, s39, s36
    s_add_u32 m0, s42, 32768
    s_nop 0
    buffer_load_dwordx4 v3, s[20:23], s39 offen lds
    s_add_u32 s39, s39, s44
    s_add_u32 m0, s42, 33792
    s_nop 0
    buffer_load_dwordx4 v3, s[20:23], s39 offen lds
    s_add_u32 s39, s39, s44
    s_add_u32 m0, s42, 34816
    s_nop 0
    buffer_load_dwordx4 v3, s[20:23], s39 offen lds
    s_add_u32 s39, s39, s44
    s_add_u32 m0, s42, 35840
    s_nop 0
    buffer_load_dwordx4 v3, s[20:23], s39 offen lds
    s_mul_i32 s39, s45, 3
    s_add_u32 s39, s39, s36
    s_add_u32 m0, s42, 49152
    s_nop 0
    buffer_load_dwordx4 v3, s[20:23], s39 offen lds
    s_add_u32 s39, s39, s44
    s_add_u32 m0, s42, 50176
    s_nop 0
    buffer_load_dwordx4 v3, s[20:23], s39 offen lds
    s_add_u32 s39, s39, s44
    s_add_u32 m0, s42, 51200
    s_nop 0
    buffer_load_dwordx4 v3, s[20:23], s39 offen lds
    s_add_u32 s39, s39, s44
    s_add_u32 m0, s42, 52224
    s_nop 0
    buffer_load_dwordx4 v3, s[20:23], s39 offen lds
    v_xor_b32 v44, 0, v24
    v_xor_b32 v45, 16, v24
    v_xor_b32 v46, 32, v24
    v_xor_b32 v47, 48, v24
    v_xor_b32 v48, 64, v24
    v_xor_b32 v49, 80, v24
    v_xor_b32 v50, 96, v24
    v_xor_b32 v51, 112, v24
    s_add_u32 m0, s43, 98304
    s_add_u32 s38, s35, 32768
    buffer_load_dwordx4 v44, s[16:19], s38 offen lds
    s_add_u32 m0, s43, 99328
    s_add_u32 s38, s35, 33792
    buffer_load_dwordx4 v45, s[16:19], s38 offen lds
    s_add_u32 m0, s43, 100352
    s_add_u32 s38, s35, 34816
    buffer_load_dwordx4 v46, s[16:19], s38 offen lds
    s_add_u32 m0, s43, 101376
    s_add_u32 s38, s35, 35840
    buffer_load_dwordx4 v47, s[16:19], s38 offen lds
    s_add_u32 m0, s43, 102400
    s_add_u32 s38, s35, 36864
    buffer_load_dwordx4 v48, s[16:19], s38 offen lds
    s_add_u32 m0, s43, 103424
    s_add_u32 s38, s35, 37888
    buffer_load_dwordx4 v49, s[16:19], s38 offen lds
    s_add_u32 m0, s43, 104448
    s_add_u32 s38, s35, 38912
    buffer_load_dwordx4 v50, s[16:19], s38 offen lds
    s_add_u32 m0, s43, 105472
    s_add_u32 s38, s35, 39936
    buffer_load_dwordx4 v51, s[16:19], s38 offen lds
    s_mov_b32 s24, s14
    s_and_b32 s25, s15, 0xffff
    s_mov_b32 s26, 20971520
    s_mov_b32 s27, 0x00020000
    v_lshrrev_b32 v21, 5, v1
    v_lshrrev_b32 v22, 2, v1
    v_and_b32 v22, 3, v22
    v_lshl_add_u32 v21, v21, 3, v22
    v_lshlrev_b32 v21, 8, v21
    v_xor_b32 v22, s34, v22
    v_lshlrev_b32 v22, 6, v22
    v_add_u32 v21, v21, v22
    v_lshrrev_b32 v22, 4, v1
    v_and_b32 v22, 1, v22
    v_lshlrev_b32 v22, 5, v22
    v_add_u32 v21, v21, v22
    v_and_b32 v22, 3, v1
    v_lshlrev_b32 v22, 3, v22
    v_add_u32 v4, v21, v22
    s_waitcnt vmcnt(32)
    v_mov_b32 v32, 0
    v_lshlrev_b32 v28, 16, v52
    v_and_b32 v29, 0xffff0000, v52
    v_lshlrev_b32 v30, 16, v60
    v_and_b32 v31, 0xffff0000, v60
    v_mul_f32 v28, v28, v30
    v_mul_f32 v29, v29, v31
    v_cvt_pk_bf16_f32 v28, v28, v29
    v_lshlrev_b32 v29, 16, v28
    v_and_b32 v28, 0xffff0000, v28
    v_add_f32 v32, v32, v29
    v_add_f32 v32, v32, v28
    v_lshlrev_b32 v28, 16, v53
    v_and_b32 v29, 0xffff0000, v53
    v_lshlrev_b32 v30, 16, v61
    v_and_b32 v31, 0xffff0000, v61
    v_mul_f32 v28, v28, v30
    v_mul_f32 v29, v29, v31
    v_cvt_pk_bf16_f32 v28, v28, v29
    v_lshlrev_b32 v29, 16, v28
    v_and_b32 v28, 0xffff0000, v28
    v_add_f32 v32, v32, v29
    v_add_f32 v32, v32, v28
    v_lshlrev_b32 v28, 16, v54
    v_and_b32 v29, 0xffff0000, v54
    v_lshlrev_b32 v30, 16, v62
    v_and_b32 v31, 0xffff0000, v62
    v_mul_f32 v28, v28, v30
    v_mul_f32 v29, v29, v31
    v_cvt_pk_bf16_f32 v28, v28, v29
    v_lshlrev_b32 v29, 16, v28
    v_and_b32 v28, 0xffff0000, v28
    v_add_f32 v32, v32, v29
    v_add_f32 v32, v32, v28
    v_lshlrev_b32 v28, 16, v55
    v_and_b32 v29, 0xffff0000, v55
    v_lshlrev_b32 v30, 16, v63
    v_and_b32 v31, 0xffff0000, v63
    v_mul_f32 v28, v28, v30
    v_mul_f32 v29, v29, v31
    v_cvt_pk_bf16_f32 v28, v28, v29
    v_lshlrev_b32 v29, 16, v28
    v_and_b32 v28, 0xffff0000, v28
    v_add_f32 v32, v32, v29
    v_add_f32 v32, v32, v28
    s_nop 1
    v_add_f32_dpp v28, v32, v32 quad_perm:[1,0,3,2] row_mask:0xf bank_mask:0xf
    v_mov_b32 v32, v28
    s_nop 1
    v_add_f32_dpp v28, v32, v32 quad_perm:[2,3,0,1] row_mask:0xf bank_mask:0xf
    v_mov_b32 v32, v28
    s_nop 1
    v_add_f32_dpp v28, v32, v32 row_half_mirror row_mask:0xf bank_mask:0xf
    v_mov_b32 v32, v28
    s_nop 1
    v_add_f32_dpp v28, v32, v32 row_mirror row_mask:0xf bank_mask:0xf
    v_mov_b32 v32, v28
    s_nop 1
    v_permlane16_swap_b32 v28, v32
    s_nop 1
    v_add_f32 v32, v28, v32
    v_mov_b32 v28, v32
    s_nop 1
    v_permlane32_swap_b32 v28, v32
    s_nop 1
    v_add_f32 v28, v28, v32
    v_cvt_pk_bf16_f32 v28, 0, v28
    v_mul_f32 v28, 0xbfb8aa3b, v28
    v_exp_f32 v28, v28
    s_nop 0
    v_add_f32 v28, 1.0, v28
    v_rcp_f32 v28, v28
    s_nop 0
    v_cvt_pk_bf16_f32 v28, 0, v28
    v_sub_f32 v29, 1.0, v28
    v_cvt_pk_bf16_f32 v29, 0, v29
    v_mov_b32 v64, v28
    v_mov_b32 v65, v29
    v_mov_b32 v32, 0
    v_lshlrev_b32 v28, 16, v56
    v_and_b32 v29, 0xffff0000, v56
    v_lshlrev_b32 v30, 16, v60
    v_and_b32 v31, 0xffff0000, v60
    v_mul_f32 v28, v28, v30
    v_mul_f32 v29, v29, v31
    v_cvt_pk_bf16_f32 v28, v28, v29
    v_lshlrev_b32 v29, 16, v28
    v_and_b32 v28, 0xffff0000, v28
    v_add_f32 v32, v32, v29
    v_add_f32 v32, v32, v28
    v_lshlrev_b32 v28, 16, v57
    v_and_b32 v29, 0xffff0000, v57
    v_lshlrev_b32 v30, 16, v61
    v_and_b32 v31, 0xffff0000, v61
    v_mul_f32 v28, v28, v30
    v_mul_f32 v29, v29, v31
    v_cvt_pk_bf16_f32 v28, v28, v29
    v_lshlrev_b32 v29, 16, v28
    v_and_b32 v28, 0xffff0000, v28
    v_add_f32 v32, v32, v29
    v_add_f32 v32, v32, v28
    v_lshlrev_b32 v28, 16, v58
    v_and_b32 v29, 0xffff0000, v58
    v_lshlrev_b32 v30, 16, v62
    v_and_b32 v31, 0xffff0000, v62
    v_mul_f32 v28, v28, v30
    v_mul_f32 v29, v29, v31
    v_cvt_pk_bf16_f32 v28, v28, v29
    v_lshlrev_b32 v29, 16, v28
    v_and_b32 v28, 0xffff0000, v28
    v_add_f32 v32, v32, v29
    v_add_f32 v32, v32, v28
    v_lshlrev_b32 v28, 16, v59
    v_and_b32 v29, 0xffff0000, v59
    v_lshlrev_b32 v30, 16, v63
    v_and_b32 v31, 0xffff0000, v63
    v_mul_f32 v28, v28, v30
    v_mul_f32 v29, v29, v31
    v_cvt_pk_bf16_f32 v28, v28, v29
    v_lshlrev_b32 v29, 16, v28
    v_and_b32 v28, 0xffff0000, v28
    v_add_f32 v32, v32, v29
    v_add_f32 v32, v32, v28
    s_nop 1
    v_add_f32_dpp v28, v32, v32 quad_perm:[1,0,3,2] row_mask:0xf bank_mask:0xf
    v_mov_b32 v32, v28
    s_nop 1
    v_add_f32_dpp v28, v32, v32 quad_perm:[2,3,0,1] row_mask:0xf bank_mask:0xf
    v_mov_b32 v32, v28
    s_nop 1
    v_add_f32_dpp v28, v32, v32 row_half_mirror row_mask:0xf bank_mask:0xf
    v_mov_b32 v32, v28
    s_nop 1
    v_add_f32_dpp v28, v32, v32 row_mirror row_mask:0xf bank_mask:0xf
    v_mov_b32 v32, v28
    s_nop 1
    v_permlane16_swap_b32 v28, v32
    s_nop 1
    v_add_f32 v32, v28, v32
    v_mov_b32 v28, v32
    s_nop 1
    v_permlane32_swap_b32 v28, v32
    s_nop 1
    v_add_f32 v28, v28, v32
    v_cvt_pk_bf16_f32 v28, 0, v28
    v_mul_f32 v28, 0xbfb8aa3b, v28
    v_exp_f32 v28, v28
    s_nop 0
    v_add_f32 v28, 1.0, v28
    v_rcp_f32 v28, v28
    s_nop 0
    v_cvt_pk_bf16_f32 v28, 0, v28
    v_sub_f32 v29, 1.0, v28
    v_cvt_pk_bf16_f32 v29, 0, v29
    v_cmp_eq_u32 vcc, 0, v1
    s_lshl_b32 s38, s41, 2
    s_add_u32 s38, s38, 13631488
    v_cndmask_b32 v28, v28, v64, vcc
    v_cndmask_b32 v29, v29, v65, vcc
    v_lshlrev_b32 v30, 2, v1
    s_add_u32 s39, s38, 8192
    s_mov_b64 exec, 3
    buffer_store_dword v28, v30, s[24:27], s38 offen sc0 sc1
    buffer_store_dword v29, v30, s[24:27], s39 offen sc0 sc1
    s_mov_b64 exec, -1
    s_lshl_b32 s38, s33, 2
    s_add_u32 s38, s38, s34
    s_cmp_ge_u32 s33, 12
    s_cbranch_scc1 L_proj_N
    s_cmp_lt_u32 s38, 32
    s_cselect_b32 s47, 1, 2
    s_cselect_b32 s39, 0, 4290904064
    s_lshl_b32 s48, s47, 10
    s_lshl_b32 s47, s47, 16
    s_lshl_b32 s38, s38, 1
    s_mul_i32 s38, s38, s47
    s_add_u32 s46, s38, s39
    s_lshl_b32 s38, s32, 2
    s_mul_i32 s38, s38, s48
    s_add_u32 s46, s46, s38
    s_waitcnt vmcnt(22)
    s_barrier
    ds_read_b64_tr_b16 v[84:85], v4 offset:0
    ds_read_b64_tr_b16 v[86:87], v4 offset:1024
    ds_read_b128 v[28:31], v13 offset:0
    ds_read_b64_tr_b16 v[88:89], v4 offset:4096
    ds_read_b64_tr_b16 v[90:91], v4 offset:5120
    ds_read_b128 v[32:35], v14 offset:0
    ds_read_b64_tr_b16 v[92:93], v4 offset:8192
    ds_read_b64_tr_b16 v[94:95], v4 offset:9216
    ds_read_b128 v[36:39], v15 offset:0
    ds_read_b64_tr_b16 v[96:97], v4 offset:12288
    ds_read_b64_tr_b16 v[98:99], v4 offset:13312
    ds_read_b128 v[40:43], v16 offset:0
    s_waitcnt lgkmcnt(9)
    v_mfma_f32_32x32x16_bf16 v[52:67], v[84:87], v[28:31], 0
    s_waitcnt lgkmcnt(6)
    v_mfma_f32_32x32x16_bf16 v[52:67], v[88:91], v[32:35], v[52:67]
    s_waitcnt lgkmcnt(3)
    v_mfma_f32_32x32x16_bf16 v[52:67], v[92:95], v[36:39], v[52:67]
    s_waitcnt lgkmcnt(0)
    v_mfma_f32_32x32x16_bf16 v[52:67], v[96:99], v[40:43], v[52:67]
    s_waitcnt vmcnt(18)
    s_barrier
    s_mul_i32 s39, s45, 4
    s_add_u32 s39, s39, s36
    s_add_u32 m0, s42, 0
    s_nop 0
    buffer_load_dwordx4 v3, s[20:23], s39 offen lds
    s_add_u32 s39, s39, s44
    s_add_u32 m0, s42, 1024
    s_nop 0
    buffer_load_dwordx4 v3, s[20:23], s39 offen lds
    s_add_u32 s39, s39, s44
    s_add_u32 m0, s42, 2048
    s_nop 0
    buffer_load_dwordx4 v3, s[20:23], s39 offen lds
    s_add_u32 s39, s39, s44
    s_add_u32 m0, s42, 3072
    s_nop 0
    buffer_load_dwordx4 v3, s[20:23], s39 offen lds
    ds_read_b64_tr_b16 v[100:101], v4 offset:16384
    ds_read_b64_tr_b16 v[102:103], v4 offset:17408
    ds_read_b128 v[28:31], v17 offset:0
    ds_read_b64_tr_b16 v[104:105], v4 offset:20480
    ds_read_b64_tr_b16 v[106:107], v4 offset:21504
    ds_read_b128 v[32:35], v18 offset:0
    ds_read_b64_tr_b16 v[108:109], v4 offset:24576
    ds_read_b64_tr_b16 v[110:111], v4 offset:25600
    ds_read_b128 v[36:39], v19 offset:0
    ds_read_b64_tr_b16 v[112:113], v4 offset:28672
    ds_read_b64_tr_b16 v[114:115], v4 offset:29696
    ds_read_b128 v[40:43], v20 offset:0
    s_waitcnt lgkmcnt(9)
    v_mfma_f32_32x32x16_bf16 v[52:67], v[100:103], v[28:31], v[52:67]
    s_waitcnt lgkmcnt(6)
    v_mfma_f32_32x32x16_bf16 v[52:67], v[104:107], v[32:35], v[52:67]
    s_waitcnt lgkmcnt(3)
    v_mfma_f32_32x32x16_bf16 v[52:67], v[108:111], v[36:39], v[52:67]
    s_waitcnt lgkmcnt(0)
    v_mfma_f32_32x32x16_bf16 v[52:67], v[112:115], v[40:43], v[52:67]
    s_waitcnt vmcnt(18)
    s_barrier
    s_mul_i32 s39, s45, 5
    s_add_u32 s39, s39, s36
    s_add_u32 m0, s42, 16384
    s_nop 0
    buffer_load_dwordx4 v3, s[20:23], s39 offen lds
    s_add_u32 s39, s39, s44
    s_add_u32 m0, s42, 17408
    s_nop 0
    buffer_load_dwordx4 v3, s[20:23], s39 offen lds
    s_add_u32 s39, s39, s44
    s_add_u32 m0, s42, 18432
    s_nop 0
    buffer_load_dwordx4 v3, s[20:23], s39 offen lds
    s_add_u32 s39, s39, s44
    s_add_u32 m0, s42, 19456
    s_nop 0
    buffer_load_dwordx4 v3, s[20:23], s39 offen lds
    ds_read_b64_tr_b16 v[116:117], v4 offset:32768
    ds_read_b64_tr_b16 v[118:119], v4 offset:33792
    ds_read_b128 v[28:31], v13 offset:256
    ds_read_b64_tr_b16 v[120:121], v4 offset:36864
    ds_read_b64_tr_b16 v[122:123], v4 offset:37888
    ds_read_b128 v[32:35], v14 offset:256
    ds_read_b64_tr_b16 v[124:125], v4 offset:40960
    ds_read_b64_tr_b16 v[126:127], v4 offset:41984
    ds_read_b128 v[36:39], v15 offset:256
    ds_read_b64_tr_b16 v[128:129], v4 offset:45056
    ds_read_b64_tr_b16 v[130:131], v4 offset:46080
    ds_read_b128 v[40:43], v16 offset:256
    s_waitcnt lgkmcnt(9)
    v_mfma_f32_32x32x16_bf16 v[52:67], v[116:119], v[28:31], v[52:67]
    s_waitcnt lgkmcnt(6)
    v_mfma_f32_32x32x16_bf16 v[52:67], v[120:123], v[32:35], v[52:67]
    s_waitcnt lgkmcnt(3)
    v_mfma_f32_32x32x16_bf16 v[52:67], v[124:127], v[36:39], v[52:67]
    s_waitcnt lgkmcnt(0)
    v_mfma_f32_32x32x16_bf16 v[52:67], v[128:131], v[40:43], v[52:67]
    s_waitcnt vmcnt(18)
    s_barrier
    s_mul_i32 s39, s45, 6
    s_add_u32 s39, s39, s36
    s_add_u32 m0, s42, 32768
    s_nop 0
    buffer_load_dwordx4 v3, s[20:23], s39 offen lds
    s_add_u32 s39, s39, s44
    s_add_u32 m0, s42, 33792
    s_nop 0
    buffer_load_dwordx4 v3, s[20:23], s39 offen lds
    s_add_u32 s39, s39, s44
    s_add_u32 m0, s42, 34816
    s_nop 0
    buffer_load_dwordx4 v3, s[20:23], s39 offen lds
    s_add_u32 s39, s39, s44
    s_add_u32 m0, s42, 35840
    s_nop 0
    buffer_load_dwordx4 v3, s[20:23], s39 offen lds
    ds_read_b64_tr_b16 v[132:133], v4 offset:49152
    ds_read_b64_tr_b16 v[134:135], v4 offset:50176
    ds_read_b128 v[28:31], v17 offset:256
    ds_read_b64_tr_b16 v[136:137], v4 offset:53248
    ds_read_b64_tr_b16 v[138:139], v4 offset:54272
    ds_read_b128 v[32:35], v18 offset:256
    ds_read_b64_tr_b16 v[140:141], v4 offset:57344
    ds_read_b64_tr_b16 v[142:143], v4 offset:58368
    ds_read_b128 v[36:39], v19 offset:256
    ds_read_b64_tr_b16 v[144:145], v4 offset:61440
    ds_read_b64_tr_b16 v[146:147], v4 offset:62464
    ds_read_b128 v[40:43], v20 offset:256
    s_waitcnt lgkmcnt(9)
    v_mfma_f32_32x32x16_bf16 v[52:67], v[132:135], v[28:31], v[52:67]
    s_waitcnt lgkmcnt(6)
    v_mfma_f32_32x32x16_bf16 v[52:67], v[136:139], v[32:35], v[52:67]
    s_waitcnt lgkmcnt(3)
    v_mfma_f32_32x32x16_bf16 v[52:67], v[140:143], v[36:39], v[52:67]
    s_waitcnt lgkmcnt(0)
    v_mfma_f32_32x32x16_bf16 v[52:67], v[144:147], v[40:43], v[52:67]
    s_waitcnt vmcnt(8)
    s_barrier
    s_mul_i32 s39, s45, 7
    s_add_u32 s39, s39, s36
    s_add_u32 m0, s42, 49152
    s_nop 0
    buffer_load_dwordx4 v3, s[20:23], s39 offen lds
    s_add_u32 s39, s39, s44
    s_add_u32 m0, s42, 50176
    s_nop 0
    buffer_load_dwordx4 v3, s[20:23], s39 offen lds
    s_add_u32 s39, s39, s44
    s_add_u32 m0, s42, 51200
    s_nop 0
    buffer_load_dwordx4 v3, s[20:23], s39 offen lds
    s_add_u32 s39, s39, s44
    s_add_u32 m0, s42, 52224
    s_nop 0
    buffer_load_dwordx4 v3, s[20:23], s39 offen lds
    ds_read_b64_tr_b16 v[148:149], v4 offset:0
    ds_read_b64_tr_b16 v[150:151], v4 offset:1024
    ds_read_b128 v[28:31], v13 offset:512
    ds_read_b64_tr_b16 v[152:153], v4 offset:4096
    ds_read_b64_tr_b16 v[154:155], v4 offset:5120
    ds_read_b128 v[32:35], v14 offset:512
    ds_read_b64_tr_b16 v[156:157], v4 offset:8192
    ds_read_b64_tr_b16 v[158:159], v4 offset:9216
    ds_read_b128 v[36:39], v15 offset:512
    ds_read_b64_tr_b16 v[160:161], v4 offset:12288
    ds_read_b64_tr_b16 v[162:163], v4 offset:13312
    ds_read_b128 v[40:43], v16 offset:512
    s_waitcnt lgkmcnt(9)
    v_mfma_f32_32x32x16_bf16 v[52:67], v[148:151], v[28:31], v[52:67]
    s_waitcnt lgkmcnt(6)
    v_mfma_f32_32x32x16_bf16 v[52:67], v[152:155], v[32:35], v[52:67]
    s_waitcnt lgkmcnt(3)
    v_mfma_f32_32x32x16_bf16 v[52:67], v[156:159], v[36:39], v[52:67]
    s_waitcnt lgkmcnt(0)
    v_mfma_f32_32x32x16_bf16 v[52:67], v[160:163], v[40:43], v[52:67]
    s_waitcnt vmcnt(8)
    s_barrier
    ds_read_b64_tr_b16 v[164:165], v4 offset:16384
    ds_read_b64_tr_b16 v[166:167], v4 offset:17408
    ds_read_b128 v[28:31], v17 offset:512
    ds_read_b64_tr_b16 v[168:169], v4 offset:20480
    ds_read_b64_tr_b16 v[170:171], v4 offset:21504
    ds_read_b128 v[32:35], v18 offset:512
    ds_read_b64_tr_b16 v[172:173], v4 offset:24576
    ds_read_b64_tr_b16 v[174:175], v4 offset:25600
    ds_read_b128 v[36:39], v19 offset:512
    ds_read_b64_tr_b16 v[176:177], v4 offset:28672
    ds_read_b64_tr_b16 v[178:179], v4 offset:29696
    ds_read_b128 v[40:43], v20 offset:512
    s_waitcnt lgkmcnt(9)
    v_mfma_f32_32x32x16_bf16 v[52:67], v[164:167], v[28:31], v[52:67]
    s_waitcnt lgkmcnt(6)
    v_mfma_f32_32x32x16_bf16 v[52:67], v[168:171], v[32:35], v[52:67]
    s_waitcnt lgkmcnt(3)
    v_mfma_f32_32x32x16_bf16 v[52:67], v[172:175], v[36:39], v[52:67]
    s_waitcnt lgkmcnt(0)
    v_mfma_f32_32x32x16_bf16 v[52:67], v[176:179], v[40:43], v[52:67]
    s_waitcnt vmcnt(4)
    s_barrier
    ds_read_b64_tr_b16 v[180:181], v4 offset:32768
    ds_read_b64_tr_b16 v[182:183], v4 offset:33792
    ds_read_b128 v[28:31], v13 offset:768
    ds_read_b64_tr_b16 v[184:185], v4 offset:36864
    ds_read_b64_tr_b16 v[186:187], v4 offset:37888
    ds_read_b128 v[32:35], v14 offset:768
    ds_read_b64_tr_b16 v[188:189], v4 offset:40960
    ds_read_b64_tr_b16 v[190:191], v4 offset:41984
    ds_read_b128 v[36:39], v15 offset:768
    ds_read_b64_tr_b16 v[192:193], v4 offset:45056
    ds_read_b64_tr_b16 v[194:195], v4 offset:46080
    ds_read_b128 v[40:43], v16 offset:768
    s_waitcnt lgkmcnt(9)
    v_mfma_f32_32x32x16_bf16 v[52:67], v[180:183], v[28:31], v[52:67]
    s_waitcnt lgkmcnt(6)
    v_mfma_f32_32x32x16_bf16 v[52:67], v[184:187], v[32:35], v[52:67]
    s_waitcnt lgkmcnt(3)
    v_mfma_f32_32x32x16_bf16 v[52:67], v[188:191], v[36:39], v[52:67]
    s_waitcnt lgkmcnt(0)
    v_mfma_f32_32x32x16_bf16 v[52:67], v[192:195], v[40:43], v[52:67]
    s_waitcnt vmcnt(0)
    s_barrier
    ds_read_b64_tr_b16 v[196:197], v4 offset:49152
    ds_read_b64_tr_b16 v[198:199], v4 offset:50176
    ds_read_b128 v[28:31], v17 offset:768
    ds_read_b64_tr_b16 v[200:201], v4 offset:53248
    ds_read_b64_tr_b16 v[202:203], v4 offset:54272
    ds_read_b128 v[32:35], v18 offset:768
    ds_read_b64_tr_b16 v[204:205], v4 offset:57344
    ds_read_b64_tr_b16 v[206:207], v4 offset:58368
    ds_read_b128 v[36:39], v19 offset:768
    ds_read_b64_tr_b16 v[208:209], v4 offset:61440
    ds_read_b64_tr_b16 v[210:211], v4 offset:62464
    ds_read_b128 v[40:43], v20 offset:768
    s_waitcnt lgkmcnt(9)
    v_mfma_f32_32x32x16_bf16 v[52:67], v[196:199], v[28:31], v[52:67]
    s_waitcnt lgkmcnt(6)
    v_mfma_f32_32x32x16_bf16 v[52:67], v[200:203], v[32:35], v[52:67]
    s_waitcnt lgkmcnt(3)
    v_mfma_f32_32x32x16_bf16 v[52:67], v[204:207], v[36:39], v[52:67]
    s_waitcnt lgkmcnt(0)
    v_mfma_f32_32x32x16_bf16 v[52:67], v[208:211], v[40:43], v[52:67]
    s_barrier
    v_xor_b32 v44, 0, v24
    v_xor_b32 v45, 16, v24
    v_xor_b32 v46, 32, v24
    v_xor_b32 v47, 48, v24
    v_xor_b32 v48, 64, v24
    v_xor_b32 v49, 80, v24
    v_xor_b32 v50, 96, v24
    v_xor_b32 v51, 112, v24
    s_add_u32 m0, s43, 0
    s_add_u32 s38, s35, 65536
    buffer_load_dwordx4 v44, s[16:19], s38 offen lds
    s_add_u32 m0, s43, 1024
    s_add_u32 s38, s35, 66560
    buffer_load_dwordx4 v45, s[16:19], s38 offen lds
    s_add_u32 m0, s43, 2048
    s_add_u32 s38, s35, 67584
    buffer_load_dwordx4 v46, s[16:19], s38 offen lds
    s_add_u32 m0, s43, 3072
    s_add_u32 s38, s35, 68608
    buffer_load_dwordx4 v47, s[16:19], s38 offen lds
    s_add_u32 m0, s43, 4096
    s_add_u32 s38, s35, 69632
    buffer_load_dwordx4 v48, s[16:19], s38 offen lds
    s_add_u32 m0, s43, 5120
    s_add_u32 s38, s35, 70656
    buffer_load_dwordx4 v49, s[16:19], s38 offen lds
    s_add_u32 m0, s43, 6144
    s_add_u32 s38, s35, 71680
    buffer_load_dwordx4 v50, s[16:19], s38 offen lds
    s_add_u32 m0, s43, 7168
    s_add_u32 s38, s35, 72704
    buffer_load_dwordx4 v51, s[16:19], s38 offen lds
    v_xor_b32 v44, 0, v24
    v_xor_b32 v45, 16, v24
    v_xor_b32 v46, 32, v24
    v_xor_b32 v47, 48, v24
    v_xor_b32 v48, 64, v24
    v_xor_b32 v49, 80, v24
    v_xor_b32 v50, 96, v24
    v_xor_b32 v51, 112, v24
    s_add_u32 m0, s43, 32768
    s_add_u32 s38, s35, 98304
    buffer_load_dwordx4 v44, s[16:19], s38 offen lds
    s_add_u32 m0, s43, 33792
    s_add_u32 s38, s35, 99328
    buffer_load_dwordx4 v45, s[16:19], s38 offen lds
    s_add_u32 m0, s43, 34816
    s_add_u32 s38, s35, 100352
    buffer_load_dwordx4 v46, s[16:19], s38 offen lds
    s_add_u32 m0, s43, 35840
    s_add_u32 s38, s35, 101376
    buffer_load_dwordx4 v47, s[16:19], s38 offen lds
    s_add_u32 m0, s43, 36864
    s_add_u32 s38, s35, 102400
    buffer_load_dwordx4 v48, s[16:19], s38 offen lds
    s_add_u32 m0, s43, 37888
    s_add_u32 s38, s35, 103424
    buffer_load_dwordx4 v49, s[16:19], s38 offen lds
    s_add_u32 m0, s43, 38912
    s_add_u32 s38, s35, 104448
    buffer_load_dwordx4 v50, s[16:19], s38 offen lds
    s_add_u32 m0, s43, 39936
    s_add_u32 s38, s35, 105472
    buffer_load_dwordx4 v51, s[16:19], s38 offen lds
    ds_read_b128 v[28:31], v13 offset:32768
    ds_read_b128 v[32:35], v14 offset:32768
    ds_read_b128 v[36:39], v15 offset:32768
    ds_read_b128 v[40:43], v16 offset:32768
    s_waitcnt lgkmcnt(3)
    v_mfma_f32_32x32x16_bf16 v[68:83], v[84:87], v[28:31], 0
    ds_read_b128 v[28:31], v17 offset:32768
    s_waitcnt lgkmcnt(3)
    v_mfma_f32_32x32x16_bf16 v[68:83], v[88:91], v[32:35], v[68:83]
    ds_read_b128 v[32:35], v18 offset:32768
    s_waitcnt lgkmcnt(3)
    v_mfma_f32_32x32x16_bf16 v[68:83], v[92:95], v[36:39], v[68:83]
    ds_read_b128 v[36:39], v19 offset:32768
    s_waitcnt lgkmcnt(3)
    v_mfma_f32_32x32x16_bf16 v[68:83], v[96:99], v[40:43], v[68:83]
    ds_read_b128 v[40:43], v20 offset:32768
    s_waitcnt lgkmcnt(3)
    v_mfma_f32_32x32x16_bf16 v[68:83], v[100:103], v[28:31], v[68:83]
    ds_read_b128 v[28:31], v13 offset:33024
    s_waitcnt lgkmcnt(3)
    v_mfma_f32_32x32x16_bf16 v[68:83], v[104:107], v[32:35], v[68:83]
    ds_read_b128 v[32:35], v14 offset:33024
    s_waitcnt lgkmcnt(3)
    v_mfma_f32_32x32x16_bf16 v[68:83], v[108:111], v[36:39], v[68:83]
    v_cvt_pk_bf16_f32 v44, v52, v53
    v_cvt_pk_bf16_f32 v45, v54, v55
    v_cvt_pk_bf16_f32 v46, v56, v57
    v_cvt_pk_bf16_f32 v47, v58, v59
    v_cvt_pk_bf16_f32 v48, v60, v61
    v_cvt_pk_bf16_f32 v49, v62, v63
    v_cvt_pk_bf16_f32 v50, v64, v65
    v_cvt_pk_bf16_f32 v51, v66, v67
    s_add_u32 s40, s46, s47
    buffer_store_dwordx4 v[44:47], v2, s[24:27], s46 offen sc0 sc1
    buffer_store_dwordx4 v[48:51], v2, s[24:27], s40 offen sc0 sc1
    s_add_u32 s46, s46, s48
    ds_read_b128 v[36:39], v15 offset:33024
    s_waitcnt lgkmcnt(3)
    v_mfma_f32_32x32x16_bf16 v[68:83], v[112:115], v[40:43], v[68:83]
    ds_read_b128 v[40:43], v16 offset:33024
    s_waitcnt lgkmcnt(3)
    v_mfma_f32_32x32x16_bf16 v[68:83], v[116:119], v[28:31], v[68:83]
    ds_read_b128 v[28:31], v17 offset:33024
    s_waitcnt lgkmcnt(3)
    v_mfma_f32_32x32x16_bf16 v[68:83], v[120:123], v[32:35], v[68:83]
    ds_read_b128 v[32:35], v18 offset:33024
    s_waitcnt lgkmcnt(3)
    v_mfma_f32_32x32x16_bf16 v[68:83], v[124:127], v[36:39], v[68:83]
    ds_read_b128 v[36:39], v19 offset:33024
    s_waitcnt lgkmcnt(3)
    v_mfma_f32_32x32x16_bf16 v[68:83], v[128:131], v[40:43], v[68:83]
    ds_read_b128 v[40:43], v20 offset:33024
    s_waitcnt lgkmcnt(3)
    v_mfma_f32_32x32x16_bf16 v[68:83], v[132:135], v[28:31], v[68:83]
    ds_read_b128 v[28:31], v13 offset:33280
    s_waitcnt lgkmcnt(3)
    v_mfma_f32_32x32x16_bf16 v[68:83], v[136:139], v[32:35], v[68:83]
    ds_read_b128 v[32:35], v14 offset:33280
    s_waitcnt lgkmcnt(3)
    v_mfma_f32_32x32x16_bf16 v[68:83], v[140:143], v[36:39], v[68:83]
    ds_read_b128 v[36:39], v15 offset:33280
    s_waitcnt lgkmcnt(3)
    v_mfma_f32_32x32x16_bf16 v[68:83], v[144:147], v[40:43], v[68:83]
    ds_read_b128 v[40:43], v16 offset:33280
    s_waitcnt lgkmcnt(3)
    v_mfma_f32_32x32x16_bf16 v[68:83], v[148:151], v[28:31], v[68:83]
    ds_read_b128 v[28:31], v17 offset:33280
    s_waitcnt lgkmcnt(3)
    v_mfma_f32_32x32x16_bf16 v[68:83], v[152:155], v[32:35], v[68:83]
    ds_read_b128 v[32:35], v18 offset:33280
    s_waitcnt lgkmcnt(3)
    v_mfma_f32_32x32x16_bf16 v[68:83], v[156:159], v[36:39], v[68:83]
    ds_read_b128 v[36:39], v19 offset:33280
    s_waitcnt lgkmcnt(3)
    v_mfma_f32_32x32x16_bf16 v[68:83], v[160:163], v[40:43], v[68:83]
    ds_read_b128 v[40:43], v20 offset:33280
    s_waitcnt lgkmcnt(3)
    v_mfma_f32_32x32x16_bf16 v[68:83], v[164:167], v[28:31], v[68:83]
    ds_read_b128 v[28:31], v13 offset:33536
    s_waitcnt lgkmcnt(3)
    v_mfma_f32_32x32x16_bf16 v[68:83], v[168:171], v[32:35], v[68:83]
    ds_read_b128 v[32:35], v14 offset:33536
    s_waitcnt lgkmcnt(3)
    v_mfma_f32_32x32x16_bf16 v[68:83], v[172:175], v[36:39], v[68:83]
    ds_read_b128 v[36:39], v15 offset:33536
    s_waitcnt lgkmcnt(3)
    v_mfma_f32_32x32x16_bf16 v[68:83], v[176:179], v[40:43], v[68:83]
    ds_read_b128 v[40:43], v16 offset:33536
    s_waitcnt lgkmcnt(3)
    v_mfma_f32_32x32x16_bf16 v[68:83], v[180:183], v[28:31], v[68:83]
    ds_read_b128 v[28:31], v17 offset:33536
    s_waitcnt lgkmcnt(3)
    v_mfma_f32_32x32x16_bf16 v[68:83], v[184:187], v[32:35], v[68:83]
    ds_read_b128 v[32:35], v18 offset:33536
    s_waitcnt lgkmcnt(3)
    v_mfma_f32_32x32x16_bf16 v[68:83], v[188:191], v[36:39], v[68:83]
    ds_read_b128 v[36:39], v19 offset:33536
    s_waitcnt lgkmcnt(3)
    v_mfma_f32_32x32x16_bf16 v[68:83], v[192:195], v[40:43], v[68:83]
    ds_read_b128 v[40:43], v20 offset:33536
    s_waitcnt lgkmcnt(3)
    v_mfma_f32_32x32x16_bf16 v[68:83], v[196:199], v[28:31], v[68:83]
    s_waitcnt lgkmcnt(2)
    v_mfma_f32_32x32x16_bf16 v[68:83], v[200:203], v[32:35], v[68:83]
    s_waitcnt lgkmcnt(1)
    v_mfma_f32_32x32x16_bf16 v[68:83], v[204:207], v[36:39], v[68:83]
    s_waitcnt lgkmcnt(0)
    v_mfma_f32_32x32x16_bf16 v[68:83], v[208:211], v[40:43], v[68:83]
    s_waitcnt vmcnt(10)
    s_barrier
    ds_read_b128 v[28:31], v5 offset:0
    ds_read_b128 v[32:35], v6 offset:0
    ds_read_b128 v[36:39], v7 offset:0
    ds_read_b128 v[40:43], v8 offset:0
    s_waitcnt lgkmcnt(3)
    v_mfma_f32_32x32x16_bf16 v[52:67], v[84:87], v[28:31], 0
    ds_read_b128 v[28:31], v9 offset:0
    s_waitcnt lgkmcnt(3)
    v_mfma_f32_32x32x16_bf16 v[52:67], v[88:91], v[32:35], v[52:67]
    ds_read_b128 v[32:35], v10 offset:0
    s_waitcnt lgkmcnt(3)
    v_mfma_f32_32x32x16_bf16 v[52:67], v[92:95], v[36:39], v[52:67]
    ds_read_b128 v[36:39], v11 offset:0
    s_waitcnt lgkmcnt(3)
    v_mfma_f32_32x32x16_bf16 v[52:67], v[96:99], v[40:43], v[52:67]
    ds_read_b128 v[40:43], v12 offset:0
    s_waitcnt lgkmcnt(3)
    v_mfma_f32_32x32x16_bf16 v[52:67], v[100:103], v[28:31], v[52:67]
    ds_read_b128 v[28:31], v5 offset:256
    s_waitcnt lgkmcnt(3)
    v_mfma_f32_32x32x16_bf16 v[52:67], v[104:107], v[32:35], v[52:67]
    ds_read_b128 v[32:35], v6 offset:256
    s_waitcnt lgkmcnt(3)
    v_mfma_f32_32x32x16_bf16 v[52:67], v[108:111], v[36:39], v[52:67]
    v_cvt_pk_bf16_f32 v44, v68, v69
    v_cvt_pk_bf16_f32 v45, v70, v71
    v_cvt_pk_bf16_f32 v46, v72, v73
    v_cvt_pk_bf16_f32 v47, v74, v75
    v_cvt_pk_bf16_f32 v48, v76, v77
    v_cvt_pk_bf16_f32 v49, v78, v79
    v_cvt_pk_bf16_f32 v50, v80, v81
    v_cvt_pk_bf16_f32 v51, v82, v83
    s_add_u32 s40, s46, s47
    buffer_store_dwordx4 v[44:47], v2, s[24:27], s46 offen sc0 sc1
    buffer_store_dwordx4 v[48:51], v2, s[24:27], s40 offen sc0 sc1
    s_add_u32 s46, s46, s48
    ds_read_b128 v[36:39], v7 offset:256
    s_waitcnt lgkmcnt(3)
    v_mfma_f32_32x32x16_bf16 v[52:67], v[112:115], v[40:43], v[52:67]
    ds_read_b128 v[40:43], v8 offset:256
    s_waitcnt lgkmcnt(3)
    v_mfma_f32_32x32x16_bf16 v[52:67], v[116:119], v[28:31], v[52:67]
    ds_read_b128 v[28:31], v9 offset:256
    s_waitcnt lgkmcnt(3)
    v_mfma_f32_32x32x16_bf16 v[52:67], v[120:123], v[32:35], v[52:67]
    ds_read_b128 v[32:35], v10 offset:256
    s_waitcnt lgkmcnt(3)
    v_mfma_f32_32x32x16_bf16 v[52:67], v[124:127], v[36:39], v[52:67]
    ds_read_b128 v[36:39], v11 offset:256
    s_waitcnt lgkmcnt(3)
    v_mfma_f32_32x32x16_bf16 v[52:67], v[128:131], v[40:43], v[52:67]
    ds_read_b128 v[40:43], v12 offset:256
    s_waitcnt lgkmcnt(3)
    v_mfma_f32_32x32x16_bf16 v[52:67], v[132:135], v[28:31], v[52:67]
    ds_read_b128 v[28:31], v5 offset:512
    s_waitcnt lgkmcnt(3)
    v_mfma_f32_32x32x16_bf16 v[52:67], v[136:139], v[32:35], v[52:67]
    ds_read_b128 v[32:35], v6 offset:512
    s_waitcnt lgkmcnt(3)
    v_mfma_f32_32x32x16_bf16 v[52:67], v[140:143], v[36:39], v[52:67]
    ds_read_b128 v[36:39], v7 offset:512
    s_waitcnt lgkmcnt(3)
    v_mfma_f32_32x32x16_bf16 v[52:67], v[144:147], v[40:43], v[52:67]
    ds_read_b128 v[40:43], v8 offset:512
    s_waitcnt lgkmcnt(3)
    v_mfma_f32_32x32x16_bf16 v[52:67], v[148:151], v[28:31], v[52:67]
    ds_read_b128 v[28:31], v9 offset:512
    s_waitcnt lgkmcnt(3)
    v_mfma_f32_32x32x16_bf16 v[52:67], v[152:155], v[32:35], v[52:67]
    ds_read_b128 v[32:35], v10 offset:512
    s_waitcnt lgkmcnt(3)
    v_mfma_f32_32x32x16_bf16 v[52:67], v[156:159], v[36:39], v[52:67]
    ds_read_b128 v[36:39], v11 offset:512
    s_waitcnt lgkmcnt(3)
    v_mfma_f32_32x32x16_bf16 v[52:67], v[160:163], v[40:43], v[52:67]
    ds_read_b128 v[40:43], v12 offset:512
    s_waitcnt lgkmcnt(3)
    v_mfma_f32_32x32x16_bf16 v[52:67], v[164:167], v[28:31], v[52:67]
    ds_read_b128 v[28:31], v5 offset:768
    s_waitcnt lgkmcnt(3)
    v_mfma_f32_32x32x16_bf16 v[52:67], v[168:171], v[32:35], v[52:67]
    ds_read_b128 v[32:35], v6 offset:768
    s_waitcnt lgkmcnt(3)
    v_mfma_f32_32x32x16_bf16 v[52:67], v[172:175], v[36:39], v[52:67]
    ds_read_b128 v[36:39], v7 offset:768
    s_waitcnt lgkmcnt(3)
    v_mfma_f32_32x32x16_bf16 v[52:67], v[176:179], v[40:43], v[52:67]
    ds_read_b128 v[40:43], v8 offset:768
    s_waitcnt lgkmcnt(3)
    v_mfma_f32_32x32x16_bf16 v[52:67], v[180:183], v[28:31], v[52:67]
    ds_read_b128 v[28:31], v9 offset:768
    s_waitcnt lgkmcnt(3)
    v_mfma_f32_32x32x16_bf16 v[52:67], v[184:187], v[32:35], v[52:67]
    ds_read_b128 v[32:35], v10 offset:768
    s_waitcnt lgkmcnt(3)
    v_mfma_f32_32x32x16_bf16 v[52:67], v[188:191], v[36:39], v[52:67]
    ds_read_b128 v[36:39], v11 offset:768
    s_waitcnt lgkmcnt(3)
    v_mfma_f32_32x32x16_bf16 v[52:67], v[192:195], v[40:43], v[52:67]
    ds_read_b128 v[40:43], v12 offset:768
    s_waitcnt lgkmcnt(3)
    v_mfma_f32_32x32x16_bf16 v[52:67], v[196:199], v[28:31], v[52:67]
    s_waitcnt lgkmcnt(2)
    v_mfma_f32_32x32x16_bf16 v[52:67], v[200:203], v[32:35], v[52:67]
    s_waitcnt lgkmcnt(1)
    v_mfma_f32_32x32x16_bf16 v[52:67], v[204:207], v[36:39], v[52:67]
    s_waitcnt lgkmcnt(0)
    v_mfma_f32_32x32x16_bf16 v[52:67], v[208:211], v[40:43], v[52:67]
    s_waitcnt vmcnt(4)
    s_barrier
    ds_read_b128 v[28:31], v5 offset:32768
    ds_read_b128 v[32:35], v6 offset:32768
    ds_read_b128 v[36:39], v7 offset:32768
    ds_read_b128 v[40:43], v8 offset:32768
    s_waitcnt lgkmcnt(3)
    v_mfma_f32_32x32x16_bf16 v[68:83], v[84:87], v[28:31], 0
    ds_read_b128 v[28:31], v9 offset:32768
    s_waitcnt lgkmcnt(3)
    v_mfma_f32_32x32x16_bf16 v[68:83], v[88:91], v[32:35], v[68:83]
    ds_read_b128 v[32:35], v10 offset:32768
    s_waitcnt lgkmcnt(3)
    v_mfma_f32_32x32x16_bf16 v[68:83], v[92:95], v[36:39], v[68:83]
    ds_read_b128 v[36:39], v11 offset:32768
    s_waitcnt lgkmcnt(3)
    v_mfma_f32_32x32x16_bf16 v[68:83], v[96:99], v[40:43], v[68:83]
    ds_read_b128 v[40:43], v12 offset:32768
    s_waitcnt lgkmcnt(3)
    v_mfma_f32_32x32x16_bf16 v[68:83], v[100:103], v[28:31], v[68:83]
    ds_read_b128 v[28:31], v5 offset:33024
    s_waitcnt lgkmcnt(3)
    v_mfma_f32_32x32x16_bf16 v[68:83], v[104:107], v[32:35], v[68:83]
    ds_read_b128 v[32:35], v6 offset:33024
    s_waitcnt lgkmcnt(3)
    v_mfma_f32_32x32x16_bf16 v[68:83], v[108:111], v[36:39], v[68:83]
    v_cvt_pk_bf16_f32 v44, v52, v53
    v_cvt_pk_bf16_f32 v45, v54, v55
    v_cvt_pk_bf16_f32 v46, v56, v57
    v_cvt_pk_bf16_f32 v47, v58, v59
    v_cvt_pk_bf16_f32 v48, v60, v61
    v_cvt_pk_bf16_f32 v49, v62, v63
    v_cvt_pk_bf16_f32 v50, v64, v65
    v_cvt_pk_bf16_f32 v51, v66, v67
    s_add_u32 s40, s46, s47
    buffer_store_dwordx4 v[44:47], v2, s[24:27], s46 offen sc0 sc1
    buffer_store_dwordx4 v[48:51], v2, s[24:27], s40 offen sc0 sc1
    s_add_u32 s46, s46, s48
    ds_read_b128 v[36:39], v7 offset:33024
    s_waitcnt lgkmcnt(3)
    v_mfma_f32_32x32x16_bf16 v[68:83], v[112:115], v[40:43], v[68:83]
    ds_read_b128 v[40:43], v8 offset:33024
    s_waitcnt lgkmcnt(3)
    v_mfma_f32_32x32x16_bf16 v[68:83], v[116:119], v[28:31], v[68:83]
    ds_read_b128 v[28:31], v9 offset:33024
    s_waitcnt lgkmcnt(3)
    v_mfma_f32_32x32x16_bf16 v[68:83], v[120:123], v[32:35], v[68:83]
    ds_read_b128 v[32:35], v10 offset:33024
    s_waitcnt lgkmcnt(3)
    v_mfma_f32_32x32x16_bf16 v[68:83], v[124:127], v[36:39], v[68:83]
    ds_read_b128 v[36:39], v11 offset:33024
    s_waitcnt lgkmcnt(3)
    v_mfma_f32_32x32x16_bf16 v[68:83], v[128:131], v[40:43], v[68:83]
    ds_read_b128 v[40:43], v12 offset:33024
    s_waitcnt lgkmcnt(3)
    v_mfma_f32_32x32x16_bf16 v[68:83], v[132:135], v[28:31], v[68:83]
    ds_read_b128 v[28:31], v5 offset:33280
    s_waitcnt lgkmcnt(3)
    v_mfma_f32_32x32x16_bf16 v[68:83], v[136:139], v[32:35], v[68:83]
    ds_read_b128 v[32:35], v6 offset:33280
    s_waitcnt lgkmcnt(3)
    v_mfma_f32_32x32x16_bf16 v[68:83], v[140:143], v[36:39], v[68:83]
    ds_read_b128 v[36:39], v7 offset:33280
    s_waitcnt lgkmcnt(3)
    v_mfma_f32_32x32x16_bf16 v[68:83], v[144:147], v[40:43], v[68:83]
    ds_read_b128 v[40:43], v8 offset:33280
    s_waitcnt lgkmcnt(3)
    v_mfma_f32_32x32x16_bf16 v[68:83], v[148:151], v[28:31], v[68:83]
    ds_read_b128 v[28:31], v9 offset:33280
    s_waitcnt lgkmcnt(3)
    v_mfma_f32_32x32x16_bf16 v[68:83], v[152:155], v[32:35], v[68:83]
    ds_read_b128 v[32:35], v10 offset:33280
    s_waitcnt lgkmcnt(3)
    v_mfma_f32_32x32x16_bf16 v[68:83], v[156:159], v[36:39], v[68:83]
    ds_read_b128 v[36:39], v11 offset:33280
    s_waitcnt lgkmcnt(3)
    v_mfma_f32_32x32x16_bf16 v[68:83], v[160:163], v[40:43], v[68:83]
    ds_read_b128 v[40:43], v12 offset:33280
    s_waitcnt lgkmcnt(3)
    v_mfma_f32_32x32x16_bf16 v[68:83], v[164:167], v[28:31], v[68:83]
    ds_read_b128 v[28:31], v5 offset:33536
    s_waitcnt lgkmcnt(3)
    v_mfma_f32_32x32x16_bf16 v[68:83], v[168:171], v[32:35], v[68:83]
    ds_read_b128 v[32:35], v6 offset:33536
    s_waitcnt lgkmcnt(3)
    v_mfma_f32_32x32x16_bf16 v[68:83], v[172:175], v[36:39], v[68:83]
    ds_read_b128 v[36:39], v7 offset:33536
    s_waitcnt lgkmcnt(3)
    v_mfma_f32_32x32x16_bf16 v[68:83], v[176:179], v[40:43], v[68:83]
    ds_read_b128 v[40:43], v8 offset:33536
    s_waitcnt lgkmcnt(3)
    v_mfma_f32_32x32x16_bf16 v[68:83], v[180:183], v[28:31], v[68:83]
    ds_read_b128 v[28:31], v9 offset:33536
    s_waitcnt lgkmcnt(3)
    v_mfma_f32_32x32x16_bf16 v[68:83], v[184:187], v[32:35], v[68:83]
    ds_read_b128 v[32:35], v10 offset:33536
    s_waitcnt lgkmcnt(3)
    v_mfma_f32_32x32x16_bf16 v[68:83], v[188:191], v[36:39], v[68:83]
    ds_read_b128 v[36:39], v11 offset:33536
    s_waitcnt lgkmcnt(3)
    v_mfma_f32_32x32x16_bf16 v[68:83], v[192:195], v[40:43], v[68:83]
    ds_read_b128 v[40:43], v12 offset:33536
    s_waitcnt lgkmcnt(3)
    v_mfma_f32_32x32x16_bf16 v[68:83], v[196:199], v[28:31], v[68:83]
    s_waitcnt lgkmcnt(2)
    v_mfma_f32_32x32x16_bf16 v[68:83], v[200:203], v[32:35], v[68:83]
    s_waitcnt lgkmcnt(1)
    v_mfma_f32_32x32x16_bf16 v[68:83], v[204:207], v[36:39], v[68:83]
    s_waitcnt lgkmcnt(0)
    v_mfma_f32_32x32x16_bf16 v[68:83], v[208:211], v[40:43], v[68:83]
    s_nop 15
    v_cvt_pk_bf16_f32 v44, v68, v69
    v_cvt_pk_bf16_f32 v45, v70, v71
    v_cvt_pk_bf16_f32 v46, v72, v73
    v_cvt_pk_bf16_f32 v47, v74, v75
    v_cvt_pk_bf16_f32 v48, v76, v77
    v_cvt_pk_bf16_f32 v49, v78, v79
    v_cvt_pk_bf16_f32 v50, v80, v81
    v_cvt_pk_bf16_f32 v51, v82, v83
    s_add_u32 s40, s46, s47
    buffer_store_dwordx4 v[44:47], v2, s[24:27], s46 offen sc0 sc1
    buffer_store_dwordx4 v[48:51], v2, s[24:27], s40 offen sc0 sc1
    s_add_u32 s46, s46, s48
    s_endpgm
L_proj_N:
    s_sub_u32 s38, s38, 48
    s_lshl_b32 s38, s38, 18
    s_add_u32 s46, s38, 4326400
    s_lshl_b32 s38, s32, 13
    s_add_u32 s46, s46, s38
    v_lshrrev_b32 v21, 4, v1
    v_and_b32 v21, 1, v21
    v_lshlrev_b32 v21, 17, v21
    v_lshrrev_b32 v22, 5, v1
    v_lshlrev_b32 v22, 9, v22
    v_add_u32 v21, v21, v22
    v_and_b32 v22, 15, v1
    v_lshlrev_b32 v22, 4, v22
    v_add_u32 v25, v21, v22
    s_waitcnt vmcnt(22)
    s_barrier
    ds_read_b64_tr_b16 v[84:85], v4 offset:0
    ds_read_b64_tr_b16 v[86:87], v4 offset:1024
    ds_read_b128 v[28:31], v13 offset:0
    ds_read_b64_tr_b16 v[88:89], v4 offset:4096
    ds_read_b64_tr_b16 v[90:91], v4 offset:5120
    ds_read_b128 v[32:35], v14 offset:0
    ds_read_b64_tr_b16 v[92:93], v4 offset:8192
    ds_read_b64_tr_b16 v[94:95], v4 offset:9216
    ds_read_b128 v[36:39], v15 offset:0
    ds_read_b64_tr_b16 v[96:97], v4 offset:12288
    ds_read_b64_tr_b16 v[98:99], v4 offset:13312
    ds_read_b128 v[40:43], v16 offset:0
    s_waitcnt lgkmcnt(9)
    v_mfma_f32_32x32x16_bf16 v[52:67], v[28:31], v[84:87], 0
    s_waitcnt lgkmcnt(6)
    v_mfma_f32_32x32x16_bf16 v[52:67], v[32:35], v[88:91], v[52:67]
    s_waitcnt lgkmcnt(3)
    v_mfma_f32_32x32x16_bf16 v[52:67], v[36:39], v[92:95], v[52:67]
    s_waitcnt lgkmcnt(0)
    v_mfma_f32_32x32x16_bf16 v[52:67], v[40:43], v[96:99], v[52:67]
    s_waitcnt vmcnt(18)
    s_barrier
    s_mul_i32 s39, s45, 4
    s_add_u32 s39, s39, s36
    s_add_u32 m0, s42, 0
    s_nop 0
    buffer_load_dwordx4 v3, s[20:23], s39 offen lds
    s_add_u32 s39, s39, s44
    s_add_u32 m0, s42, 1024
    s_nop 0
    buffer_load_dwordx4 v3, s[20:23], s39 offen lds
    s_add_u32 s39, s39, s44
    s_add_u32 m0, s42, 2048
    s_nop 0
    buffer_load_dwordx4 v3, s[20:23], s39 offen lds
    s_add_u32 s39, s39, s44
    s_add_u32 m0, s42, 3072
    s_nop 0
    buffer_load_dwordx4 v3, s[20:23], s39 offen lds
    ds_read_b64_tr_b16 v[100:101], v4 offset:16384
    ds_read_b64_tr_b16 v[102:103], v4 offset:17408
    ds_read_b128 v[28:31], v17 offset:0
    ds_read_b64_tr_b16 v[104:105], v4 offset:20480
    ds_read_b64_tr_b16 v[106:107], v4 offset:21504
    ds_read_b128 v[32:35], v18 offset:0
    ds_read_b64_tr_b16 v[108:109], v4 offset:24576
    ds_read_b64_tr_b16 v[110:111], v4 offset:25600
    ds_read_b128 v[36:39], v19 offset:0
    ds_read_b64_tr_b16 v[112:113], v4 offset:28672
    ds_read_b64_tr_b16 v[114:115], v4 offset:29696
    ds_read_b128 v[40:43], v20 offset:0
    s_waitcnt lgkmcnt(9)
    v_mfma_f32_32x32x16_bf16 v[52:67], v[28:31], v[100:103], v[52:67]
    s_waitcnt lgkmcnt(6)
    v_mfma_f32_32x32x16_bf16 v[52:67], v[32:35], v[104:107], v[52:67]
    s_waitcnt lgkmcnt(3)
    v_mfma_f32_32x32x16_bf16 v[52:67], v[36:39], v[108:111], v[52:67]
    s_waitcnt lgkmcnt(0)
    v_mfma_f32_32x32x16_bf16 v[52:67], v[40:43], v[112:115], v[52:67]
    s_waitcnt vmcnt(18)
    s_barrier
    s_mul_i32 s39, s45, 5
    s_add_u32 s39, s39, s36
    s_add_u32 m0, s42, 16384
    s_nop 0
    buffer_load_dwordx4 v3, s[20:23], s39 offen lds
    s_add_u32 s39, s39, s44
    s_add_u32 m0, s42, 17408
    s_nop 0
    buffer_load_dwordx4 v3, s[20:23], s39 offen lds
    s_add_u32 s39, s39, s44
    s_add_u32 m0, s42, 18432
    s_nop 0
    buffer_load_dwordx4 v3, s[20:23], s39 offen lds
    s_add_u32 s39, s39, s44
    s_add_u32 m0, s42, 19456
    s_nop 0
    buffer_load_dwordx4 v3, s[20:23], s39 offen lds
    ds_read_b64_tr_b16 v[116:117], v4 offset:32768
    ds_read_b64_tr_b16 v[118:119], v4 offset:33792
    ds_read_b128 v[28:31], v13 offset:256
    ds_read_b64_tr_b16 v[120:121], v4 offset:36864
    ds_read_b64_tr_b16 v[122:123], v4 offset:37888
    ds_read_b128 v[32:35], v14 offset:256
    ds_read_b64_tr_b16 v[124:125], v4 offset:40960
    ds_read_b64_tr_b16 v[126:127], v4 offset:41984
    ds_read_b128 v[36:39], v15 offset:256
    ds_read_b64_tr_b16 v[128:129], v4 offset:45056
    ds_read_b64_tr_b16 v[130:131], v4 offset:46080
    ds_read_b128 v[40:43], v16 offset:256
    s_waitcnt lgkmcnt(9)
    v_mfma_f32_32x32x16_bf16 v[52:67], v[28:31], v[116:119], v[52:67]
    s_waitcnt lgkmcnt(6)
    v_mfma_f32_32x32x16_bf16 v[52:67], v[32:35], v[120:123], v[52:67]
    s_waitcnt lgkmcnt(3)
    v_mfma_f32_32x32x16_bf16 v[52:67], v[36:39], v[124:127], v[52:67]
    s_waitcnt lgkmcnt(0)
    v_mfma_f32_32x32x16_bf16 v[52:67], v[40:43], v[128:131], v[52:67]
    s_waitcnt vmcnt(18)
    s_barrier
    s_mul_i32 s39, s45, 6
    s_add_u32 s39, s39, s36
    s_add_u32 m0, s42, 32768
    s_nop 0
    buffer_load_dwordx4 v3, s[20:23], s39 offen lds
    s_add_u32 s39, s39, s44
    s_add_u32 m0, s42, 33792
    s_nop 0
    buffer_load_dwordx4 v3, s[20:23], s39 offen lds
    s_add_u32 s39, s39, s44
    s_add_u32 m0, s42, 34816
    s_nop 0
    buffer_load_dwordx4 v3, s[20:23], s39 offen lds
    s_add_u32 s39, s39, s44
    s_add_u32 m0, s42, 35840
    s_nop 0
    buffer_load_dwordx4 v3, s[20:23], s39 offen lds
    ds_read_b64_tr_b16 v[132:133], v4 offset:49152
    ds_read_b64_tr_b16 v[134:135], v4 offset:50176
    ds_read_b128 v[28:31], v17 offset:256
    ds_read_b64_tr_b16 v[136:137], v4 offset:53248
    ds_read_b64_tr_b16 v[138:139], v4 offset:54272
    ds_read_b128 v[32:35], v18 offset:256
    ds_read_b64_tr_b16 v[140:141], v4 offset:57344
    ds_read_b64_tr_b16 v[142:143], v4 offset:58368
    ds_read_b128 v[36:39], v19 offset:256
    ds_read_b64_tr_b16 v[144:145], v4 offset:61440
    ds_read_b64_tr_b16 v[146:147], v4 offset:62464
    ds_read_b128 v[40:43], v20 offset:256
    s_waitcnt lgkmcnt(9)
    v_mfma_f32_32x32x16_bf16 v[52:67], v[28:31], v[132:135], v[52:67]
    s_waitcnt lgkmcnt(6)
    v_mfma_f32_32x32x16_bf16 v[52:67], v[32:35], v[136:139], v[52:67]
    s_waitcnt lgkmcnt(3)
    v_mfma_f32_32x32x16_bf16 v[52:67], v[36:39], v[140:143], v[52:67]
    s_waitcnt lgkmcnt(0)
    v_mfma_f32_32x32x16_bf16 v[52:67], v[40:43], v[144:147], v[52:67]
    s_waitcnt vmcnt(8)
    s_barrier
    s_mul_i32 s39, s45, 7
    s_add_u32 s39, s39, s36
    s_add_u32 m0, s42, 49152
    s_nop 0
    buffer_load_dwordx4 v3, s[20:23], s39 offen lds
    s_add_u32 s39, s39, s44
    s_add_u32 m0, s42, 50176
    s_nop 0
    buffer_load_dwordx4 v3, s[20:23], s39 offen lds
    s_add_u32 s39, s39, s44
    s_add_u32 m0, s42, 51200
    s_nop 0
    buffer_load_dwordx4 v3, s[20:23], s39 offen lds
    s_add_u32 s39, s39, s44
    s_add_u32 m0, s42, 52224
    s_nop 0
    buffer_load_dwordx4 v3, s[20:23], s39 offen lds
    ds_read_b64_tr_b16 v[148:149], v4 offset:0
    ds_read_b64_tr_b16 v[150:151], v4 offset:1024
    ds_read_b128 v[28:31], v13 offset:512
    ds_read_b64_tr_b16 v[152:153], v4 offset:4096
    ds_read_b64_tr_b16 v[154:155], v4 offset:5120
    ds_read_b128 v[32:35], v14 offset:512
    ds_read_b64_tr_b16 v[156:157], v4 offset:8192
    ds_read_b64_tr_b16 v[158:159], v4 offset:9216
    ds_read_b128 v[36:39], v15 offset:512
    ds_read_b64_tr_b16 v[160:161], v4 offset:12288
    ds_read_b64_tr_b16 v[162:163], v4 offset:13312
    ds_read_b128 v[40:43], v16 offset:512
    s_waitcnt lgkmcnt(9)
    v_mfma_f32_32x32x16_bf16 v[52:67], v[28:31], v[148:151], v[52:67]
    s_waitcnt lgkmcnt(6)
    v_mfma_f32_32x32x16_bf16 v[52:67], v[32:35], v[152:155], v[52:67]
    s_waitcnt lgkmcnt(3)
    v_mfma_f32_32x32x16_bf16 v[52:67], v[36:39], v[156:159], v[52:67]
    s_waitcnt lgkmcnt(0)
    v_mfma_f32_32x32x16_bf16 v[52:67], v[40:43], v[160:163], v[52:67]
    s_waitcnt vmcnt(8)
    s_barrier
    ds_read_b64_tr_b16 v[164:165], v4 offset:16384
    ds_read_b64_tr_b16 v[166:167], v4 offset:17408
    ds_read_b128 v[28:31], v17 offset:512
    ds_read_b64_tr_b16 v[168:169], v4 offset:20480
    ds_read_b64_tr_b16 v[170:171], v4 offset:21504
    ds_read_b128 v[32:35], v18 offset:512
    ds_read_b64_tr_b16 v[172:173], v4 offset:24576
    ds_read_b64_tr_b16 v[174:175], v4 offset:25600
    ds_read_b128 v[36:39], v19 offset:512
    ds_read_b64_tr_b16 v[176:177], v4 offset:28672
    ds_read_b64_tr_b16 v[178:179], v4 offset:29696
    ds_read_b128 v[40:43], v20 offset:512
    s_waitcnt lgkmcnt(9)
    v_mfma_f32_32x32x16_bf16 v[52:67], v[28:31], v[164:167], v[52:67]
    s_waitcnt lgkmcnt(6)
    v_mfma_f32_32x32x16_bf16 v[52:67], v[32:35], v[168:171], v[52:67]
    s_waitcnt lgkmcnt(3)
    v_mfma_f32_32x32x16_bf16 v[52:67], v[36:39], v[172:175], v[52:67]
    s_waitcnt lgkmcnt(0)
    v_mfma_f32_32x32x16_bf16 v[52:67], v[40:43], v[176:179], v[52:67]
    s_waitcnt vmcnt(4)
    s_barrier
    ds_read_b64_tr_b16 v[180:181], v4 offset:32768
    ds_read_b64_tr_b16 v[182:183], v4 offset:33792
    ds_read_b128 v[28:31], v13 offset:768
    ds_read_b64_tr_b16 v[184:185], v4 offset:36864
    ds_read_b64_tr_b16 v[186:187], v4 offset:37888
    ds_read_b128 v[32:35], v14 offset:768
    ds_read_b64_tr_b16 v[188:189], v4 offset:40960
    ds_read_b64_tr_b16 v[190:191], v4 offset:41984
    ds_read_b128 v[36:39], v15 offset:768
    ds_read_b64_tr_b16 v[192:193], v4 offset:45056
    ds_read_b64_tr_b16 v[194:195], v4 offset:46080
    ds_read_b128 v[40:43], v16 offset:768
    s_waitcnt lgkmcnt(9)
    v_mfma_f32_32x32x16_bf16 v[52:67], v[28:31], v[180:183], v[52:67]
    s_waitcnt lgkmcnt(6)
    v_mfma_f32_32x32x16_bf16 v[52:67], v[32:35], v[184:187], v[52:67]
    s_waitcnt lgkmcnt(3)
    v_mfma_f32_32x32x16_bf16 v[52:67], v[36:39], v[188:191], v[52:67]
    s_waitcnt lgkmcnt(0)
    v_mfma_f32_32x32x16_bf16 v[52:67], v[40:43], v[192:195], v[52:67]
    s_waitcnt vmcnt(0)
    s_barrier
    ds_read_b64_tr_b16 v[196:197], v4 offset:49152
    ds_read_b64_tr_b16 v[198:199], v4 offset:50176
    ds_read_b128 v[28:31], v17 offset:768
    ds_read_b64_tr_b16 v[200:201], v4 offset:53248
    ds_read_b64_tr_b16 v[202:203], v4 offset:54272
    ds_read_b128 v[32:35], v18 offset:768
    ds_read_b64_tr_b16 v[204:205], v4 offset:57344
    ds_read_b64_tr_b16 v[206:207], v4 offset:58368
    ds_read_b128 v[36:39], v19 offset:768
    ds_read_b64_tr_b16 v[208:209], v4 offset:61440
    ds_read_b64_tr_b16 v[210:211], v4 offset:62464
    ds_read_b128 v[40:43], v20 offset:768
    s_waitcnt lgkmcnt(9)
    v_mfma_f32_32x32x16_bf16 v[52:67], v[28:31], v[196:199], v[52:67]
    s_waitcnt lgkmcnt(6)
    v_mfma_f32_32x32x16_bf16 v[52:67], v[32:35], v[200:203], v[52:67]
    s_waitcnt lgkmcnt(3)
    v_mfma_f32_32x32x16_bf16 v[52:67], v[36:39], v[204:207], v[52:67]
    s_waitcnt lgkmcnt(0)
    v_mfma_f32_32x32x16_bf16 v[52:67], v[40:43], v[208:211], v[52:67]
    s_barrier
    v_xor_b32 v44, 0, v24
    v_xor_b32 v45, 16, v24
    v_xor_b32 v46, 32, v24
    v_xor_b32 v47, 48, v24
    v_xor_b32 v48, 64, v24
    v_xor_b32 v49, 80, v24
    v_xor_b32 v50, 96, v24
    v_xor_b32 v51, 112, v24
    s_add_u32 m0, s43, 0
    s_add_u32 s38, s35, 65536
    buffer_load_dwordx4 v44, s[16:19], s38 offen lds
    s_add_u32 m0, s43, 1024
    s_add_u32 s38, s35, 66560
    buffer_load_dwordx4 v45, s[16:19], s38 offen lds
    s_add_u32 m0, s43, 2048
    s_add_u32 s38, s35, 67584
    buffer_load_dwordx4 v46, s[16:19], s38 offen lds
    s_add_u32 m0, s43, 3072
    s_add_u32 s38, s35, 68608
    buffer_load_dwordx4 v47, s[16:19], s38 offen lds
    s_add_u32 m0, s43, 4096
    s_add_u32 s38, s35, 69632
    buffer_load_dwordx4 v48, s[16:19], s38 offen lds
    s_add_u32 m0, s43, 5120
    s_add_u32 s38, s35, 70656
    buffer_load_dwordx4 v49, s[16:19], s38 offen lds
    s_add_u32 m0, s43, 6144
    s_add_u32 s38, s35, 71680
    buffer_load_dwordx4 v50, s[16:19], s38 offen lds
    s_add_u32 m0, s43, 7168
    s_add_u32 s38, s35, 72704
    buffer_load_dwordx4 v51, s[16:19], s38 offen lds
    v_xor_b32 v44, 0, v24
    v_xor_b32 v45, 16, v24
    v_xor_b32 v46, 32, v24
    v_xor_b32 v47, 48, v24
    v_xor_b32 v48, 64, v24
    v_xor_b32 v49, 80, v24
    v_xor_b32 v50, 96, v24
    v_xor_b32 v51, 112, v24
    s_add_u32 m0, s43, 32768
    s_add_u32 s38, s35, 98304
    buffer_load_dwordx4 v44, s[16:19], s38 offen lds
    s_add_u32 m0, s43, 33792
    s_add_u32 s38, s35, 99328
    buffer_load_dwordx4 v45, s[16:19], s38 offen lds
    s_add_u32 m0, s43, 34816
    s_add_u32 s38, s35, 100352
    buffer_load_dwordx4 v46, s[16:19], s38 offen lds
    s_add_u32 m0, s43, 35840
    s_add_u32 s38, s35, 101376
    buffer_load_dwordx4 v47, s[16:19], s38 offen lds
    s_add_u32 m0, s43, 36864
    s_add_u32 s38, s35, 102400
    buffer_load_dwordx4 v48, s[16:19], s38 offen lds
    s_add_u32 m0, s43, 37888
    s_add_u32 s38, s35, 103424
    buffer_load_dwordx4 v49, s[16:19], s38 offen lds
    s_add_u32 m0, s43, 38912
    s_add_u32 s38, s35, 104448
    buffer_load_dwordx4 v50, s[16:19], s38 offen lds
    s_add_u32 m0, s43, 39936
    s_add_u32 s38, s35, 105472
    buffer_load_dwordx4 v51, s[16:19], s38 offen lds
    ds_read_b128 v[28:31], v13 offset:32768
    ds_read_b128 v[32:35], v14 offset:32768
    ds_read_b128 v[36:39], v15 offset:32768
    ds_read_b128 v[40:43], v16 offset:32768
    s_waitcnt lgkmcnt(3)
    v_mfma_f32_32x32x16_bf16 v[68:83], v[28:31], v[84:87], 0
    ds_read_b128 v[28:31], v17 offset:32768
    s_waitcnt lgkmcnt(3)
    v_mfma_f32_32x32x16_bf16 v[68:83], v[32:35], v[88:91], v[68:83]
    ds_read_b128 v[32:35], v18 offset:32768
    s_waitcnt lgkmcnt(3)
    v_mfma_f32_32x32x16_bf16 v[68:83], v[36:39], v[92:95], v[68:83]
    ds_read_b128 v[36:39], v19 offset:32768
    s_waitcnt lgkmcnt(3)
    v_mfma_f32_32x32x16_bf16 v[68:83], v[40:43], v[96:99], v[68:83]
    ds_read_b128 v[40:43], v20 offset:32768
    s_waitcnt lgkmcnt(3)
    v_mfma_f32_32x32x16_bf16 v[68:83], v[28:31], v[100:103], v[68:83]
    ds_read_b128 v[28:31], v13 offset:33024
    s_waitcnt lgkmcnt(3)
    v_mfma_f32_32x32x16_bf16 v[68:83], v[32:35], v[104:107], v[68:83]
    ds_read_b128 v[32:35], v14 offset:33024
    s_waitcnt lgkmcnt(3)
    v_mfma_f32_32x32x16_bf16 v[68:83], v[36:39], v[108:111], v[68:83]
    v_cvt_pk_bf16_f32 v44, v52, v53
    v_cvt_pk_bf16_f32 v45, v54, v55
    v_cvt_pk_bf16_f32 v46, v56, v57
    v_cvt_pk_bf16_f32 v47, v58, v59
    v_cvt_pk_bf16_f32 v48, v60, v61
    v_cvt_pk_bf16_f32 v49, v62, v63
    v_cvt_pk_bf16_f32 v50, v64, v65
    v_cvt_pk_bf16_f32 v51, v66, v67
    buffer_store_dwordx4 v[44:47], v25, s[24:27], s46 offen sc0 sc1
    buffer_store_dwordx4 v[48:51], v25, s[24:27], s46 offen offset:256 sc0 sc1
    s_add_u32 s46, s46, 2048
    ds_read_b128 v[36:39], v15 offset:33024
    s_waitcnt lgkmcnt(3)
    v_mfma_f32_32x32x16_bf16 v[68:83], v[40:43], v[112:115], v[68:83]
    ds_read_b128 v[40:43], v16 offset:33024
    s_waitcnt lgkmcnt(3)
    v_mfma_f32_32x32x16_bf16 v[68:83], v[28:31], v[116:119], v[68:83]
    ds_read_b128 v[28:31], v17 offset:33024
    s_waitcnt lgkmcnt(3)
    v_mfma_f32_32x32x16_bf16 v[68:83], v[32:35], v[120:123], v[68:83]
    ds_read_b128 v[32:35], v18 offset:33024
    s_waitcnt lgkmcnt(3)
    v_mfma_f32_32x32x16_bf16 v[68:83], v[36:39], v[124:127], v[68:83]
    ds_read_b128 v[36:39], v19 offset:33024
    s_waitcnt lgkmcnt(3)
    v_mfma_f32_32x32x16_bf16 v[68:83], v[40:43], v[128:131], v[68:83]
    ds_read_b128 v[40:43], v20 offset:33024
    s_waitcnt lgkmcnt(3)
    v_mfma_f32_32x32x16_bf16 v[68:83], v[28:31], v[132:135], v[68:83]
    ds_read_b128 v[28:31], v13 offset:33280
    s_waitcnt lgkmcnt(3)
    v_mfma_f32_32x32x16_bf16 v[68:83], v[32:35], v[136:139], v[68:83]
    ds_read_b128 v[32:35], v14 offset:33280
    s_waitcnt lgkmcnt(3)
    v_mfma_f32_32x32x16_bf16 v[68:83], v[36:39], v[140:143], v[68:83]
    ds_read_b128 v[36:39], v15 offset:33280
    s_waitcnt lgkmcnt(3)
    v_mfma_f32_32x32x16_bf16 v[68:83], v[40:43], v[144:147], v[68:83]
    ds_read_b128 v[40:43], v16 offset:33280
    s_waitcnt lgkmcnt(3)
    v_mfma_f32_32x32x16_bf16 v[68:83], v[28:31], v[148:151], v[68:83]
    ds_read_b128 v[28:31], v17 offset:33280
    s_waitcnt lgkmcnt(3)
    v_mfma_f32_32x32x16_bf16 v[68:83], v[32:35], v[152:155], v[68:83]
    ds_read_b128 v[32:35], v18 offset:33280
    s_waitcnt lgkmcnt(3)
    v_mfma_f32_32x32x16_bf16 v[68:83], v[36:39], v[156:159], v[68:83]
    ds_read_b128 v[36:39], v19 offset:33280
    s_waitcnt lgkmcnt(3)
    v_mfma_f32_32x32x16_bf16 v[68:83], v[40:43], v[160:163], v[68:83]
    ds_read_b128 v[40:43], v20 offset:33280
    s_waitcnt lgkmcnt(3)
    v_mfma_f32_32x32x16_bf16 v[68:83], v[28:31], v[164:167], v[68:83]
    ds_read_b128 v[28:31], v13 offset:33536
    s_waitcnt lgkmcnt(3)
    v_mfma_f32_32x32x16_bf16 v[68:83], v[32:35], v[168:171], v[68:83]
    ds_read_b128 v[32:35], v14 offset:33536
    s_waitcnt lgkmcnt(3)
    v_mfma_f32_32x32x16_bf16 v[68:83], v[36:39], v[172:175], v[68:83]
    ds_read_b128 v[36:39], v15 offset:33536
    s_waitcnt lgkmcnt(3)
    v_mfma_f32_32x32x16_bf16 v[68:83], v[40:43], v[176:179], v[68:83]
    ds_read_b128 v[40:43], v16 offset:33536
    s_waitcnt lgkmcnt(3)
    v_mfma_f32_32x32x16_bf16 v[68:83], v[28:31], v[180:183], v[68:83]
    ds_read_b128 v[28:31], v17 offset:33536
    s_waitcnt lgkmcnt(3)
    v_mfma_f32_32x32x16_bf16 v[68:83], v[32:35], v[184:187], v[68:83]
    ds_read_b128 v[32:35], v18 offset:33536
    s_waitcnt lgkmcnt(3)
    v_mfma_f32_32x32x16_bf16 v[68:83], v[36:39], v[188:191], v[68:83]
    ds_read_b128 v[36:39], v19 offset:33536
    s_waitcnt lgkmcnt(3)
    v_mfma_f32_32x32x16_bf16 v[68:83], v[40:43], v[192:195], v[68:83]
    ds_read_b128 v[40:43], v20 offset:33536
    s_waitcnt lgkmcnt(3)
    v_mfma_f32_32x32x16_bf16 v[68:83], v[28:31], v[196:199], v[68:83]
    s_waitcnt lgkmcnt(2)
    v_mfma_f32_32x32x16_bf16 v[68:83], v[32:35], v[200:203], v[68:83]
    s_waitcnt lgkmcnt(1)
    v_mfma_f32_32x32x16_bf16 v[68:83], v[36:39], v[204:207], v[68:83]
    s_waitcnt lgkmcnt(0)
    v_mfma_f32_32x32x16_bf16 v[68:83], v[40:43], v[208:211], v[68:83]
    s_waitcnt vmcnt(10)
    s_barrier
    ds_read_b128 v[28:31], v5 offset:0
    ds_read_b128 v[32:35], v6 offset:0
    ds_read_b128 v[36:39], v7 offset:0
    ds_read_b128 v[40:43], v8 offset:0
    s_waitcnt lgkmcnt(3)
    v_mfma_f32_32x32x16_bf16 v[52:67], v[28:31], v[84:87], 0
    ds_read_b128 v[28:31], v9 offset:0
    s_waitcnt lgkmcnt(3)
    v_mfma_f32_32x32x16_bf16 v[52:67], v[32:35], v[88:91], v[52:67]
    ds_read_b128 v[32:35], v10 offset:0
    s_waitcnt lgkmcnt(3)
    v_mfma_f32_32x32x16_bf16 v[52:67], v[36:39], v[92:95], v[52:67]
    ds_read_b128 v[36:39], v11 offset:0
    s_waitcnt lgkmcnt(3)
    v_mfma_f32_32x32x16_bf16 v[52:67], v[40:43], v[96:99], v[52:67]
    ds_read_b128 v[40:43], v12 offset:0
    s_waitcnt lgkmcnt(3)
    v_mfma_f32_32x32x16_bf16 v[52:67], v[28:31], v[100:103], v[52:67]
    ds_read_b128 v[28:31], v5 offset:256
    s_waitcnt lgkmcnt(3)
    v_mfma_f32_32x32x16_bf16 v[52:67], v[32:35], v[104:107], v[52:67]
    ds_read_b128 v[32:35], v6 offset:256
    s_waitcnt lgkmcnt(3)
    v_mfma_f32_32x32x16_bf16 v[52:67], v[36:39], v[108:111], v[52:67]
    v_cvt_pk_bf16_f32 v44, v68, v69
    v_cvt_pk_bf16_f32 v45, v70, v71
    v_cvt_pk_bf16_f32 v46, v72, v73
    v_cvt_pk_bf16_f32 v47, v74, v75
    v_cvt_pk_bf16_f32 v48, v76, v77
    v_cvt_pk_bf16_f32 v49, v78, v79
    v_cvt_pk_bf16_f32 v50, v80, v81
    v_cvt_pk_bf16_f32 v51, v82, v83
    buffer_store_dwordx4 v[44:47], v25, s[24:27], s46 offen sc0 sc1
    buffer_store_dwordx4 v[48:51], v25, s[24:27], s46 offen offset:256 sc0 sc1
    s_add_u32 s46, s46, 2048
    ds_read_b128 v[36:39], v7 offset:256
    s_waitcnt lgkmcnt(3)
    v_mfma_f32_32x32x16_bf16 v[52:67], v[40:43], v[112:115], v[52:67]
    ds_read_b128 v[40:43], v8 offset:256
    s_waitcnt lgkmcnt(3)
    v_mfma_f32_32x32x16_bf16 v[52:67], v[28:31], v[116:119], v[52:67]
    ds_read_b128 v[28:31], v9 offset:256
    s_waitcnt lgkmcnt(3)
    v_mfma_f32_32x32x16_bf16 v[52:67], v[32:35], v[120:123], v[52:67]
    ds_read_b128 v[32:35], v10 offset:256
    s_waitcnt lgkmcnt(3)
    v_mfma_f32_32x32x16_bf16 v[52:67], v[36:39], v[124:127], v[52:67]
    ds_read_b128 v[36:39], v11 offset:256
    s_waitcnt lgkmcnt(3)
    v_mfma_f32_32x32x16_bf16 v[52:67], v[40:43], v[128:131], v[52:67]
    ds_read_b128 v[40:43], v12 offset:256
    s_waitcnt lgkmcnt(3)
    v_mfma_f32_32x32x16_bf16 v[52:67], v[28:31], v[132:135], v[52:67]
    ds_read_b128 v[28:31], v5 offset:512
    s_waitcnt lgkmcnt(3)
    v_mfma_f32_32x32x16_bf16 v[52:67], v[32:35], v[136:139], v[52:67]
    ds_read_b128 v[32:35], v6 offset:512
    s_waitcnt lgkmcnt(3)
    v_mfma_f32_32x32x16_bf16 v[52:67], v[36:39], v[140:143], v[52:67]
    ds_read_b128 v[36:39], v7 offset:512
    s_waitcnt lgkmcnt(3)
    v_mfma_f32_32x32x16_bf16 v[52:67], v[40:43], v[144:147], v[52:67]
    ds_read_b128 v[40:43], v8 offset:512
    s_waitcnt lgkmcnt(3)
    v_mfma_f32_32x32x16_bf16 v[52:67], v[28:31], v[148:151], v[52:67]
    ds_read_b128 v[28:31], v9 offset:512
    s_waitcnt lgkmcnt(3)
    v_mfma_f32_32x32x16_bf16 v[52:67], v[32:35], v[152:155], v[52:67]
    ds_read_b128 v[32:35], v10 offset:512
    s_waitcnt lgkmcnt(3)
    v_mfma_f32_32x32x16_bf16 v[52:67], v[36:39], v[156:159], v[52:67]
    ds_read_b128 v[36:39], v11 offset:512
    s_waitcnt lgkmcnt(3)
    v_mfma_f32_32x32x16_bf16 v[52:67], v[40:43], v[160:163], v[52:67]
    ds_read_b128 v[40:43], v12 offset:512
    s_waitcnt lgkmcnt(3)
    v_mfma_f32_32x32x16_bf16 v[52:67], v[28:31], v[164:167], v[52:67]
    ds_read_b128 v[28:31], v5 offset:768
    s_waitcnt lgkmcnt(3)
    v_mfma_f32_32x32x16_bf16 v[52:67], v[32:35], v[168:171], v[52:67]
    ds_read_b128 v[32:35], v6 offset:768
    s_waitcnt lgkmcnt(3)
    v_mfma_f32_32x32x16_bf16 v[52:67], v[36:39], v[172:175], v[52:67]
    ds_read_b128 v[36:39], v7 offset:768
    s_waitcnt lgkmcnt(3)
    v_mfma_f32_32x32x16_bf16 v[52:67], v[40:43], v[176:179], v[52:67]
    ds_read_b128 v[40:43], v8 offset:768
    s_waitcnt lgkmcnt(3)
    v_mfma_f32_32x32x16_bf16 v[52:67], v[28:31], v[180:183], v[52:67]
    ds_read_b128 v[28:31], v9 offset:768
    s_waitcnt lgkmcnt(3)
    v_mfma_f32_32x32x16_bf16 v[52:67], v[32:35], v[184:187], v[52:67]
    ds_read_b128 v[32:35], v10 offset:768
    s_waitcnt lgkmcnt(3)
    v_mfma_f32_32x32x16_bf16 v[52:67], v[36:39], v[188:191], v[52:67]
    ds_read_b128 v[36:39], v11 offset:768
    s_waitcnt lgkmcnt(3)
    v_mfma_f32_32x32x16_bf16 v[52:67], v[40:43], v[192:195], v[52:67]
    ds_read_b128 v[40:43], v12 offset:768
    s_waitcnt lgkmcnt(3)
    v_mfma_f32_32x32x16_bf16 v[52:67], v[28:31], v[196:199], v[52:67]
    s_waitcnt lgkmcnt(2)
    v_mfma_f32_32x32x16_bf16 v[52:67], v[32:35], v[200:203], v[52:67]
    s_waitcnt lgkmcnt(1)
    v_mfma_f32_32x32x16_bf16 v[52:67], v[36:39], v[204:207], v[52:67]
    s_waitcnt lgkmcnt(0)
    v_mfma_f32_32x32x16_bf16 v[52:67], v[40:43], v[208:211], v[52:67]
    s_waitcnt vmcnt(4)
    s_barrier
    ds_read_b128 v[28:31], v5 offset:32768
    ds_read_b128 v[32:35], v6 offset:32768
    ds_read_b128 v[36:39], v7 offset:32768
    ds_read_b128 v[40:43], v8 offset:32768
    s_waitcnt lgkmcnt(3)
    v_mfma_f32_32x32x16_bf16 v[68:83], v[28:31], v[84:87], 0
    ds_read_b128 v[28:31], v9 offset:32768
    s_waitcnt lgkmcnt(3)
    v_mfma_f32_32x32x16_bf16 v[68:83], v[32:35], v[88:91], v[68:83]
    ds_read_b128 v[32:35], v10 offset:32768
    s_waitcnt lgkmcnt(3)
    v_mfma_f32_32x32x16_bf16 v[68:83], v[36:39], v[92:95], v[68:83]
    ds_read_b128 v[36:39], v11 offset:32768
    s_waitcnt lgkmcnt(3)
    v_mfma_f32_32x32x16_bf16 v[68:83], v[40:43], v[96:99], v[68:83]
    ds_read_b128 v[40:43], v12 offset:32768
    s_waitcnt lgkmcnt(3)
    v_mfma_f32_32x32x16_bf16 v[68:83], v[28:31], v[100:103], v[68:83]
    ds_read_b128 v[28:31], v5 offset:33024
    s_waitcnt lgkmcnt(3)
    v_mfma_f32_32x32x16_bf16 v[68:83], v[32:35], v[104:107], v[68:83]
    ds_read_b128 v[32:35], v6 offset:33024
    s_waitcnt lgkmcnt(3)
    v_mfma_f32_32x32x16_bf16 v[68:83], v[36:39], v[108:111], v[68:83]
    v_cvt_pk_bf16_f32 v44, v52, v53
    v_cvt_pk_bf16_f32 v45, v54, v55
    v_cvt_pk_bf16_f32 v46, v56, v57
    v_cvt_pk_bf16_f32 v47, v58, v59
    v_cvt_pk_bf16_f32 v48, v60, v61
    v_cvt_pk_bf16_f32 v49, v62, v63
    v_cvt_pk_bf16_f32 v50, v64, v65
    v_cvt_pk_bf16_f32 v51, v66, v67
    buffer_store_dwordx4 v[44:47], v25, s[24:27], s46 offen sc0 sc1
    buffer_store_dwordx4 v[48:51], v25, s[24:27], s46 offen offset:256 sc0 sc1
    s_add_u32 s46, s46, 2048
    ds_read_b128 v[36:39], v7 offset:33024
    s_waitcnt lgkmcnt(3)
    v_mfma_f32_32x32x16_bf16 v[68:83], v[40:43], v[112:115], v[68:83]
    ds_read_b128 v[40:43], v8 offset:33024
    s_waitcnt lgkmcnt(3)
    v_mfma_f32_32x32x16_bf16 v[68:83], v[28:31], v[116:119], v[68:83]
    ds_read_b128 v[28:31], v9 offset:33024
    s_waitcnt lgkmcnt(3)
    v_mfma_f32_32x32x16_bf16 v[68:83], v[32:35], v[120:123], v[68:83]
    ds_read_b128 v[32:35], v10 offset:33024
    s_waitcnt lgkmcnt(3)
    v_mfma_f32_32x32x16_bf16 v[68:83], v[36:39], v[124:127], v[68:83]
    ds_read_b128 v[36:39], v11 offset:33024
    s_waitcnt lgkmcnt(3)
    v_mfma_f32_32x32x16_bf16 v[68:83], v[40:43], v[128:131], v[68:83]
    ds_read_b128 v[40:43], v12 offset:33024
    s_waitcnt lgkmcnt(3)
    v_mfma_f32_32x32x16_bf16 v[68:83], v[28:31], v[132:135], v[68:83]
    ds_read_b128 v[28:31], v5 offset:33280
    s_waitcnt lgkmcnt(3)
    v_mfma_f32_32x32x16_bf16 v[68:83], v[32:35], v[136:139], v[68:83]
    ds_read_b128 v[32:35], v6 offset:33280
    s_waitcnt lgkmcnt(3)
    v_mfma_f32_32x32x16_bf16 v[68:83], v[36:39], v[140:143], v[68:83]
    ds_read_b128 v[36:39], v7 offset:33280
    s_waitcnt lgkmcnt(3)
    v_mfma_f32_32x32x16_bf16 v[68:83], v[40:43], v[144:147], v[68:83]
    ds_read_b128 v[40:43], v8 offset:33280
    s_waitcnt lgkmcnt(3)
    v_mfma_f32_32x32x16_bf16 v[68:83], v[28:31], v[148:151], v[68:83]
    ds_read_b128 v[28:31], v9 offset:33280
    s_waitcnt lgkmcnt(3)
    v_mfma_f32_32x32x16_bf16 v[68:83], v[32:35], v[152:155], v[68:83]
    ds_read_b128 v[32:35], v10 offset:33280
    s_waitcnt lgkmcnt(3)
    v_mfma_f32_32x32x16_bf16 v[68:83], v[36:39], v[156:159], v[68:83]
    ds_read_b128 v[36:39], v11 offset:33280
    s_waitcnt lgkmcnt(3)
    v_mfma_f32_32x32x16_bf16 v[68:83], v[40:43], v[160:163], v[68:83]
    ds_read_b128 v[40:43], v12 offset:33280
    s_waitcnt lgkmcnt(3)
    v_mfma_f32_32x32x16_bf16 v[68:83], v[28:31], v[164:167], v[68:83]
    ds_read_b128 v[28:31], v5 offset:33536
    s_waitcnt lgkmcnt(3)
    v_mfma_f32_32x32x16_bf16 v[68:83], v[32:35], v[168:171], v[68:83]
    ds_read_b128 v[32:35], v6 offset:33536
    s_waitcnt lgkmcnt(3)
    v_mfma_f32_32x32x16_bf16 v[68:83], v[36:39], v[172:175], v[68:83]
    ds_read_b128 v[36:39], v7 offset:33536
    s_waitcnt lgkmcnt(3)
    v_mfma_f32_32x32x16_bf16 v[68:83], v[40:43], v[176:179], v[68:83]
    ds_read_b128 v[40:43], v8 offset:33536
    s_waitcnt lgkmcnt(3)
    v_mfma_f32_32x32x16_bf16 v[68:83], v[28:31], v[180:183], v[68:83]
    ds_read_b128 v[28:31], v9 offset:33536
    s_waitcnt lgkmcnt(3)
    v_mfma_f32_32x32x16_bf16 v[68:83], v[32:35], v[184:187], v[68:83]
    ds_read_b128 v[32:35], v10 offset:33536
    s_waitcnt lgkmcnt(3)
    v_mfma_f32_32x32x16_bf16 v[68:83], v[36:39], v[188:191], v[68:83]
    ds_read_b128 v[36:39], v11 offset:33536
    s_waitcnt lgkmcnt(3)
    v_mfma_f32_32x32x16_bf16 v[68:83], v[40:43], v[192:195], v[68:83]
    ds_read_b128 v[40:43], v12 offset:33536
    s_waitcnt lgkmcnt(3)
    v_mfma_f32_32x32x16_bf16 v[68:83], v[28:31], v[196:199], v[68:83]
    s_waitcnt lgkmcnt(2)
    v_mfma_f32_32x32x16_bf16 v[68:83], v[32:35], v[200:203], v[68:83]
    s_waitcnt lgkmcnt(1)
    v_mfma_f32_32x32x16_bf16 v[68:83], v[36:39], v[204:207], v[68:83]
    s_waitcnt lgkmcnt(0)
    v_mfma_f32_32x32x16_bf16 v[68:83], v[40:43], v[208:211], v[68:83]
    s_nop 15
    v_cvt_pk_bf16_f32 v44, v68, v69
    v_cvt_pk_bf16_f32 v45, v70, v71
    v_cvt_pk_bf16_f32 v46, v72, v73
    v_cvt_pk_bf16_f32 v47, v74, v75
    v_cvt_pk_bf16_f32 v48, v76, v77
    v_cvt_pk_bf16_f32 v49, v78, v79
    v_cvt_pk_bf16_f32 v50, v80, v81
    v_cvt_pk_bf16_f32 v51, v82, v83
    buffer_store_dwordx4 v[44:47], v25, s[24:27], s46 offen sc0 sc1
    buffer_store_dwordx4 v[48:51], v25, s[24:27], s46 offen offset:256 sc0 sc1
    s_add_u32 s46, s46, 2048
    s_endpgm
L_proj_special:
    s_cmp_ge_u32 s33, 8
    s_cbranch_scc1 L_proj_end
    s_waitcnt lgkmcnt(0)
    s_mov_b32 s24, s14
    s_and_b32 s25, s15, 0xffff
    s_mov_b32 s26, 20971520
    s_mov_b32 s27, 0x00020000
    s_cmp_lt_u32 s33, 4
    s_cselect_b32 s20, s8, s10
    s_cselect_b32 s39, s9, s11
    s_and_b32 s21, s39, 0xffff
    s_mov_b32 s22, 16384
    s_mov_b32 s23, 0x00020000
    s_mov_b32 m0, 131072
    s_mov_b32 s38, 0
    buffer_load_dwordx4 v2, s[20:23], s38 offen lds
    s_mov_b32 m0, 132096
    s_mov_b32 s38, 1024
    buffer_load_dwordx4 v2, s[20:23], s38 offen lds
    s_mov_b32 m0, 133120
    s_mov_b32 s38, 2048
    buffer_load_dwordx4 v2, s[20:23], s38 offen lds
    s_mov_b32 m0, 134144
    s_mov_b32 s38, 3072
    buffer_load_dwordx4 v2, s[20:23], s38 offen lds
    s_mov_b32 m0, 135168
    s_mov_b32 s38, 4096
    buffer_load_dwordx4 v2, s[20:23], s38 offen lds
    s_mov_b32 m0, 136192
    s_mov_b32 s38, 5120
    buffer_load_dwordx4 v2, s[20:23], s38 offen lds
    s_mov_b32 m0, 137216
    s_mov_b32 s38, 6144
    buffer_load_dwordx4 v2, s[20:23], s38 offen lds
    s_mov_b32 m0, 138240
    s_mov_b32 s38, 7168
    buffer_load_dwordx4 v2, s[20:23], s38 offen lds
    s_mov_b32 m0, 139264
    s_mov_b32 s38, 8192
    buffer_load_dwordx4 v2, s[20:23], s38 offen lds
    s_mov_b32 m0, 140288
    s_mov_b32 s38, 9216
    buffer_load_dwordx4 v2, s[20:23], s38 offen lds
    s_mov_b32 m0, 141312
    s_mov_b32 s38, 10240
    buffer_load_dwordx4 v2, s[20:23], s38 offen lds
    s_mov_b32 m0, 142336
    s_mov_b32 s38, 11264
    buffer_load_dwordx4 v2, s[20:23], s38 offen lds
    s_mov_b32 m0, 143360
    s_mov_b32 s38, 12288
    buffer_load_dwordx4 v2, s[20:23], s38 offen lds
    s_mov_b32 m0, 144384
    s_mov_b32 s38, 13312
    buffer_load_dwordx4 v2, s[20:23], s38 offen lds
    s_mov_b32 m0, 145408
    s_mov_b32 s38, 14336
    buffer_load_dwordx4 v2, s[20:23], s38 offen lds
    s_mov_b32 m0, 146432
    s_mov_b32 s38, 15360
    buffer_load_dwordx4 v2, s[20:23], s38 offen lds
    v_lshrrev_b32 v21, 5, v1
    v_lshrrev_b32 v22, 2, v1
    v_and_b32 v22, 3, v22
    v_lshl_add_u32 v21, v21, 3, v22
    v_lshlrev_b32 v21, 5, v21
    v_and_b32 v22, 3, v1
    v_lshlrev_b32 v22, 3, v22
    v_add_u32 v21, v21, v22
    v_add_u32 v4, 131072, v21
    s_and_b32 s38, s33, 3
    s_lshl_b32 s39, s32, 2
    s_add_u32 s39, s39, s38
    s_lshl_b32 s46, s39, 11
    s_add_u32 s46, s46, 4194304
    v_lshrrev_b32 v22, 5, v1
    v_lshlrev_b32 v22, 9, v22
    v_and_b32 v21, 15, v1
    v_lshlrev_b32 v21, 4, v21
    v_add_u32 v21, v21, v22
    v_and_b32 v22, 16, v1
    v_mov_b32 v23, 0x40000000
    v_cmp_eq_u32 vcc, 0, v22
    s_nop 1
    v_cndmask_b32 v25, v23, v21, vcc
    s_waitcnt vmcnt(0)
    s_barrier
    ds_read_b64_tr_b16 v[84:85], v4 offset:0
    ds_read_b64_tr_b16 v[86:87], v4 offset:128
    ds_read_b64_tr_b16 v[88:89], v4 offset:512
    ds_read_b64_tr_b16 v[90:91], v4 offset:640
    ds_read_b64_tr_b16 v[92:93], v4 offset:1024
    ds_read_b64_tr_b16 v[94:95], v4 offset:1152
    ds_read_b64_tr_b16 v[96:97], v4 offset:1536
    ds_read_b64_tr_b16 v[98:99], v4 offset:1664
    s_waitcnt lgkmcnt(0)
    s_barrier
    ds_read_b64_tr_b16 v[100:101], v4 offset:2048
    ds_read_b64_tr_b16 v[102:103], v4 offset:2176
    ds_read_b64_tr_b16 v[104:105], v4 offset:2560
    ds_read_b64_tr_b16 v[106:107], v4 offset:2688
    ds_read_b64_tr_b16 v[108:109], v4 offset:3072
    ds_read_b64_tr_b16 v[110:111], v4 offset:3200
    ds_read_b64_tr_b16 v[112:113], v4 offset:3584
    ds_read_b64_tr_b16 v[114:115], v4 offset:3712
    s_waitcnt lgkmcnt(0)
    s_barrier
    ds_read_b64_tr_b16 v[116:117], v4 offset:4096
    ds_read_b64_tr_b16 v[118:119], v4 offset:4224
    ds_read_b64_tr_b16 v[120:121], v4 offset:4608
    ds_read_b64_tr_b16 v[122:123], v4 offset:4736
    ds_read_b64_tr_b16 v[124:125], v4 offset:5120
    ds_read_b64_tr_b16 v[126:127], v4 offset:5248
    ds_read_b64_tr_b16 v[128:129], v4 offset:5632
    ds_read_b64_tr_b16 v[130:131], v4 offset:5760
    s_waitcnt lgkmcnt(0)
    s_barrier
    ds_read_b64_tr_b16 v[132:133], v4 offset:6144
    ds_read_b64_tr_b16 v[134:135], v4 offset:6272
    ds_read_b64_tr_b16 v[136:137], v4 offset:6656
    ds_read_b64_tr_b16 v[138:139], v4 offset:6784
    ds_read_b64_tr_b16 v[140:141], v4 offset:7168
    ds_read_b64_tr_b16 v[142:143], v4 offset:7296
    ds_read_b64_tr_b16 v[144:145], v4 offset:7680
    ds_read_b64_tr_b16 v[146:147], v4 offset:7808
    s_waitcnt lgkmcnt(0)
    s_barrier
    ds_read_b64_tr_b16 v[148:149], v4 offset:8192
    ds_read_b64_tr_b16 v[150:151], v4 offset:8320
    ds_read_b64_tr_b16 v[152:153], v4 offset:8704
    ds_read_b64_tr_b16 v[154:155], v4 offset:8832
    ds_read_b64_tr_b16 v[156:157], v4 offset:9216
    ds_read_b64_tr_b16 v[158:159], v4 offset:9344
    ds_read_b64_tr_b16 v[160:161], v4 offset:9728
    ds_read_b64_tr_b16 v[162:163], v4 offset:9856
    s_waitcnt lgkmcnt(0)
    s_barrier
    ds_read_b64_tr_b16 v[164:165], v4 offset:10240
    ds_read_b64_tr_b16 v[166:167], v4 offset:10368
    ds_read_b64_tr_b16 v[168:169], v4 offset:10752
    ds_read_b64_tr_b16 v[170:171], v4 offset:10880
    ds_read_b64_tr_b16 v[172:173], v4 offset:11264
    ds_read_b64_tr_b16 v[174:175], v4 offset:11392
    ds_read_b64_tr_b16 v[176:177], v4 offset:11776
    ds_read_b64_tr_b16 v[178:179], v4 offset:11904
    s_waitcnt lgkmcnt(0)
    s_barrier
    ds_read_b64_tr_b16 v[180:181], v4 offset:12288
    ds_read_b64_tr_b16 v[182:183], v4 offset:12416
    ds_read_b64_tr_b16 v[184:185], v4 offset:12800
    ds_read_b64_tr_b16 v[186:187], v4 offset:12928
    ds_read_b64_tr_b16 v[188:189], v4 offset:13312
    ds_read_b64_tr_b16 v[190:191], v4 offset:13440
    ds_read_b64_tr_b16 v[192:193], v4 offset:13824
    ds_read_b64_tr_b16 v[194:195], v4 offset:13952
    s_waitcnt lgkmcnt(0)
    s_barrier
    ds_read_b64_tr_b16 v[196:197], v4 offset:14336
    ds_read_b64_tr_b16 v[198:199], v4 offset:14464
    ds_read_b64_tr_b16 v[200:201], v4 offset:14848
    ds_read_b64_tr_b16 v[202:203], v4 offset:14976
    ds_read_b64_tr_b16 v[204:205], v4 offset:15360
    ds_read_b64_tr_b16 v[206:207], v4 offset:15488
    ds_read_b64_tr_b16 v[208:209], v4 offset:15872
    ds_read_b64_tr_b16 v[210:211], v4 offset:16000
    s_waitcnt lgkmcnt(0)
    s_barrier
L_proj_sp0:
    s_cmp_lg_u32 s38, 0
    s_cbranch_scc1 L_proj_sp1
    s_cmp_ge_u32 s33, 4
    s_cbranch_scc1 L_proj_spN0
    ds_read_b128 v[28:31], v13 offset:0
    ds_read_b128 v[32:35], v14 offset:0
    ds_read_b128 v[36:39], v15 offset:0
    ds_read_b128 v[40:43], v16 offset:0
    s_waitcnt lgkmcnt(3)
    v_mfma_f32_32x32x16_bf16 v[52:67], v[84:87], v[28:31], 0
    ds_read_b128 v[28:31], v17 offset:0
    s_waitcnt lgkmcnt(3)
    v_mfma_f32_32x32x16_bf16 v[52:67], v[88:91], v[32:35], v[52:67]
    ds_read_b128 v[32:35], v18 offset:0
    s_waitcnt lgkmcnt(3)
    v_mfma_f32_32x32x16_bf16 v[52:67], v[92:95], v[36:39], v[52:67]
    ds_read_b128 v[36:39], v19 offset:0
    s_waitcnt lgkmcnt(3)
    v_mfma_f32_32x32x16_bf16 v[52:67], v[96:99], v[40:43], v[52:67]
    ds_read_b128 v[40:43], v20 offset:0
    s_waitcnt lgkmcnt(3)
    v_mfma_f32_32x32x16_bf16 v[52:67], v[100:103], v[28:31], v[52:67]
    ds_read_b128 v[28:31], v13 offset:256
    s_waitcnt lgkmcnt(3)
    v_mfma_f32_32x32x16_bf16 v[52:67], v[104:107], v[32:35], v[52:67]
    ds_read_b128 v[32:35], v14 offset:256
    s_waitcnt lgkmcnt(3)
    v_mfma_f32_32x32x16_bf16 v[52:67], v[108:111], v[36:39], v[52:67]
    ds_read_b128 v[36:39], v15 offset:256
    s_waitcnt lgkmcnt(3)
    v_mfma_f32_32x32x16_bf16 v[52:67], v[112:115], v[40:43], v[52:67]
    ds_read_b128 v[40:43], v16 offset:256
    s_waitcnt lgkmcnt(3)
    v_mfma_f32_32x32x16_bf16 v[52:67], v[116:119], v[28:31], v[52:67]
    ds_read_b128 v[28:31], v17 offset:256
    s_waitcnt lgkmcnt(3)
    v_mfma_f32_32x32x16_bf16 v[52:67], v[120:123], v[32:35], v[52:67]
    ds_read_b128 v[32:35], v18 offset:256
    s_waitcnt lgkmcnt(3)
    v_mfma_f32_32x32x16_bf16 v[52:67], v[124:127], v[36:39], v[52:67]
    ds_read_b128 v[36:39], v19 offset:256
    s_waitcnt lgkmcnt(3)
    v_mfma_f32_32x32x16_bf16 v[52:67], v[128:131], v[40:43], v[52:67]
    ds_read_b128 v[40:43], v20 offset:256
    s_waitcnt lgkmcnt(3)
    v_mfma_f32_32x32x16_bf16 v[52:67], v[132:135], v[28:31], v[52:67]
    ds_read_b128 v[28:31], v13 offset:512
    s_waitcnt lgkmcnt(3)
    v_mfma_f32_32x32x16_bf16 v[52:67], v[136:139], v[32:35], v[52:67]
    ds_read_b128 v[32:35], v14 offset:512
    s_waitcnt lgkmcnt(3)
    v_mfma_f32_32x32x16_bf16 v[52:67], v[140:143], v[36:39], v[52:67]
    ds_read_b128 v[36:39], v15 offset:512
    s_waitcnt lgkmcnt(3)
    v_mfma_f32_32x32x16_bf16 v[52:67], v[144:147], v[40:43], v[52:67]
    ds_read_b128 v[40:43], v16 offset:512
    s_waitcnt lgkmcnt(3)
    v_mfma_f32_32x32x16_bf16 v[52:67], v[148:151], v[28:31], v[52:67]
    ds_read_b128 v[28:31], v17 offset:512
    s_waitcnt lgkmcnt(3)
    v_mfma_f32_32x32x16_bf16 v[52:67], v[152:155], v[32:35], v[52:67]
    ds_read_b128 v[32:35], v18 offset:512
    s_waitcnt lgkmcnt(3)
    v_mfma_f32_32x32x16_bf16 v[52:67], v[156:159], v[36:39], v[52:67]
    ds_read_b128 v[36:39], v19 offset:512
    s_waitcnt lgkmcnt(3)
    v_mfma_f32_32x32x16_bf16 v[52:67], v[160:163], v[40:43], v[52:67]
    ds_read_b128 v[40:43], v20 offset:512
    s_waitcnt lgkmcnt(3)
    v_mfma_f32_32x32x16_bf16 v[52:67], v[164:167], v[28:31], v[52:67]
    ds_read_b128 v[28:31], v13 offset:768
    s_waitcnt lgkmcnt(3)
    v_mfma_f32_32x32x16_bf16 v[52:67], v[168:171], v[32:35], v[52:67]
    ds_read_b128 v[32:35], v14 offset:768
    s_waitcnt lgkmcnt(3)
    v_mfma_f32_32x32x16_bf16 v[52:67], v[172:175], v[36:39], v[52:67]
    ds_read_b128 v[36:39], v15 offset:768
    s_waitcnt lgkmcnt(3)
    v_mfma_f32_32x32x16_bf16 v[52:67], v[176:179], v[40:43], v[52:67]
    ds_read_b128 v[40:43], v16 offset:768
    s_waitcnt lgkmcnt(3)
    v_mfma_f32_32x32x16_bf16 v[52:67], v[180:183], v[28:31], v[52:67]
    ds_read_b128 v[28:31], v17 offset:768
    s_waitcnt lgkmcnt(3)
    v_mfma_f32_32x32x16_bf16 v[52:67], v[184:187], v[32:35], v[52:67]
    ds_read_b128 v[32:35], v18 offset:768
    s_waitcnt lgkmcnt(3)
    v_mfma_f32_32x32x16_bf16 v[52:67], v[188:191], v[36:39], v[52:67]
    ds_read_b128 v[36:39], v19 offset:768
    s_waitcnt lgkmcnt(3)
    v_mfma_f32_32x32x16_bf16 v[52:67], v[192:195], v[40:43], v[52:67]
    ds_read_b128 v[40:43], v20 offset:768
    s_waitcnt lgkmcnt(3)
    v_mfma_f32_32x32x16_bf16 v[52:67], v[196:199], v[28:31], v[52:67]
    s_waitcnt lgkmcnt(2)
    v_mfma_f32_32x32x16_bf16 v[52:67], v[200:203], v[32:35], v[52:67]
    s_waitcnt lgkmcnt(1)
    v_mfma_f32_32x32x16_bf16 v[52:67], v[204:207], v[36:39], v[52:67]
    s_waitcnt lgkmcnt(0)
    v_mfma_f32_32x32x16_bf16 v[52:67], v[208:211], v[40:43], v[52:67]
    s_nop 15
    v_cvt_pk_bf16_f32 v44, v52, v53
    v_cvt_pk_bf16_f32 v45, v54, v55
    v_cvt_pk_bf16_f32 v46, v56, v57
    v_cvt_pk_bf16_f32 v47, v58, v59
    buffer_store_dwordx4 v[44:47], v2, s[24:27], s46 offen sc0 sc1
    s_endpgm
L_proj_spN0:
    ds_read_b128 v[28:31], v13 offset:0
    ds_read_b128 v[32:35], v14 offset:0
    ds_read_b128 v[36:39], v15 offset:0
    ds_read_b128 v[40:43], v16 offset:0
    s_waitcnt lgkmcnt(3)
    v_mfma_f32_32x32x16_bf16 v[52:67], v[28:31], v[84:87], 0
    ds_read_b128 v[28:31], v17 offset:0
    s_waitcnt lgkmcnt(3)
    v_mfma_f32_32x32x16_bf16 v[52:67], v[32:35], v[88:91], v[52:67]
    ds_read_b128 v[32:35], v18 offset:0
    s_waitcnt lgkmcnt(3)
    v_mfma_f32_32x32x16_bf16 v[52:67], v[36:39], v[92:95], v[52:67]
    ds_read_b128 v[36:39], v19 offset:0
    s_waitcnt lgkmcnt(3)
    v_mfma_f32_32x32x16_bf16 v[52:67], v[40:43], v[96:99], v[52:67]
    ds_read_b128 v[40:43], v20 offset:0
    s_waitcnt lgkmcnt(3)
    v_mfma_f32_32x32x16_bf16 v[52:67], v[28:31], v[100:103], v[52:67]
    ds_read_b128 v[28:31], v13 offset:256
    s_waitcnt lgkmcnt(3)
    v_mfma_f32_32x32x16_bf16 v[52:67], v[32:35], v[104:107], v[52:67]
    ds_read_b128 v[32:35], v14 offset:256
    s_waitcnt lgkmcnt(3)
    v_mfma_f32_32x32x16_bf16 v[52:67], v[36:39], v[108:111], v[52:67]
    ds_read_b128 v[36:39], v15 offset:256
    s_waitcnt lgkmcnt(3)
    v_mfma_f32_32x32x16_bf16 v[52:67], v[40:43], v[112:115], v[52:67]
    ds_read_b128 v[40:43], v16 offset:256
    s_waitcnt lgkmcnt(3)
    v_mfma_f32_32x32x16_bf16 v[52:67], v[28:31], v[116:119], v[52:67]
    ds_read_b128 v[28:31], v17 offset:256
    s_waitcnt lgkmcnt(3)
    v_mfma_f32_32x32x16_bf16 v[52:67], v[32:35], v[120:123], v[52:67]
    ds_read_b128 v[32:35], v18 offset:256
    s_waitcnt lgkmcnt(3)
    v_mfma_f32_32x32x16_bf16 v[52:67], v[36:39], v[124:127], v[52:67]
    ds_read_b128 v[36:39], v19 offset:256
    s_waitcnt lgkmcnt(3)
    v_mfma_f32_32x32x16_bf16 v[52:67], v[40:43], v[128:131], v[52:67]
    ds_read_b128 v[40:43], v20 offset:256
    s_waitcnt lgkmcnt(3)
    v_mfma_f32_32x32x16_bf16 v[52:67], v[28:31], v[132:135], v[52:67]
    ds_read_b128 v[28:31], v13 offset:512
    s_waitcnt lgkmcnt(3)
    v_mfma_f32_32x32x16_bf16 v[52:67], v[32:35], v[136:139], v[52:67]
    ds_read_b128 v[32:35], v14 offset:512
    s_waitcnt lgkmcnt(3)
    v_mfma_f32_32x32x16_bf16 v[52:67], v[36:39], v[140:143], v[52:67]
    ds_read_b128 v[36:39], v15 offset:512
    s_waitcnt lgkmcnt(3)
    v_mfma_f32_32x32x16_bf16 v[52:67], v[40:43], v[144:147], v[52:67]
    ds_read_b128 v[40:43], v16 offset:512
    s_waitcnt lgkmcnt(3)
    v_mfma_f32_32x32x16_bf16 v[52:67], v[28:31], v[148:151], v[52:67]
    ds_read_b128 v[28:31], v17 offset:512
    s_waitcnt lgkmcnt(3)
    v_mfma_f32_32x32x16_bf16 v[52:67], v[32:35], v[152:155], v[52:67]
    ds_read_b128 v[32:35], v18 offset:512
    s_waitcnt lgkmcnt(3)
    v_mfma_f32_32x32x16_bf16 v[52:67], v[36:39], v[156:159], v[52:67]
    ds_read_b128 v[36:39], v19 offset:512
    s_waitcnt lgkmcnt(3)
    v_mfma_f32_32x32x16_bf16 v[52:67], v[40:43], v[160:163], v[52:67]
    ds_read_b128 v[40:43], v20 offset:512
    s_waitcnt lgkmcnt(3)
    v_mfma_f32_32x32x16_bf16 v[52:67], v[28:31], v[164:167], v[52:67]
    ds_read_b128 v[28:31], v13 offset:768
    s_waitcnt lgkmcnt(3)
    v_mfma_f32_32x32x16_bf16 v[52:67], v[32:35], v[168:171], v[52:67]
    ds_read_b128 v[32:35], v14 offset:768
    s_waitcnt lgkmcnt(3)
    v_mfma_f32_32x32x16_bf16 v[52:67], v[36:39], v[172:175], v[52:67]
    ds_read_b128 v[36:39], v15 offset:768
    s_waitcnt lgkmcnt(3)
    v_mfma_f32_32x32x16_bf16 v[52:67], v[40:43], v[176:179], v[52:67]
    ds_read_b128 v[40:43], v16 offset:768
    s_waitcnt lgkmcnt(3)
    v_mfma_f32_32x32x16_bf16 v[52:67], v[28:31], v[180:183], v[52:67]
    ds_read_b128 v[28:31], v17 offset:768
    s_waitcnt lgkmcnt(3)
    v_mfma_f32_32x32x16_bf16 v[52:67], v[32:35], v[184:187], v[52:67]
    ds_read_b128 v[32:35], v18 offset:768
    s_waitcnt lgkmcnt(3)
    v_mfma_f32_32x32x16_bf16 v[52:67], v[36:39], v[188:191], v[52:67]
    ds_read_b128 v[36:39], v19 offset:768
    s_waitcnt lgkmcnt(3)
    v_mfma_f32_32x32x16_bf16 v[52:67], v[40:43], v[192:195], v[52:67]
    ds_read_b128 v[40:43], v20 offset:768
    s_waitcnt lgkmcnt(3)
    v_mfma_f32_32x32x16_bf16 v[52:67], v[28:31], v[196:199], v[52:67]
    s_waitcnt lgkmcnt(2)
    v_mfma_f32_32x32x16_bf16 v[52:67], v[32:35], v[200:203], v[52:67]
    s_waitcnt lgkmcnt(1)
    v_mfma_f32_32x32x16_bf16 v[52:67], v[36:39], v[204:207], v[52:67]
    s_waitcnt lgkmcnt(0)
    v_mfma_f32_32x32x16_bf16 v[52:67], v[40:43], v[208:211], v[52:67]
    s_nop 15
    v_cvt_pk_bf16_f32 v44, v52, v53
    v_cvt_pk_bf16_f32 v45, v54, v55
    v_cvt_pk_bf16_f32 v46, v56, v57
    v_cvt_pk_bf16_f32 v47, v58, v59
    v_cvt_pk_bf16_f32 v48, v60, v61
    v_cvt_pk_bf16_f32 v49, v62, v63
    v_cvt_pk_bf16_f32 v50, v64, v65
    v_cvt_pk_bf16_f32 v51, v66, v67
    buffer_store_dwordx4 v[44:47], v25, s[24:27], s46 offen offset:1024 sc0 sc1
    buffer_store_dwordx4 v[48:51], v25, s[24:27], s46 offen offset:1280 sc0 sc1
    s_endpgm
L_proj_sp1:
    s_cmp_lg_u32 s38, 1
    s_cbranch_scc1 L_proj_sp2
    s_cmp_ge_u32 s33, 4
    s_cbranch_scc1 L_proj_spN1
    ds_read_b128 v[28:31], v13 offset:32768
    ds_read_b128 v[32:35], v14 offset:32768
    ds_read_b128 v[36:39], v15 offset:32768
    ds_read_b128 v[40:43], v16 offset:32768
    s_waitcnt lgkmcnt(3)
    v_mfma_f32_32x32x16_bf16 v[52:67], v[84:87], v[28:31], 0
    ds_read_b128 v[28:31], v17 offset:32768
    s_waitcnt lgkmcnt(3)
    v_mfma_f32_32x32x16_bf16 v[52:67], v[88:91], v[32:35], v[52:67]
    ds_read_b128 v[32:35], v18 offset:32768
    s_waitcnt lgkmcnt(3)
    v_mfma_f32_32x32x16_bf16 v[52:67], v[92:95], v[36:39], v[52:67]
    ds_read_b128 v[36:39], v19 offset:32768
    s_waitcnt lgkmcnt(3)
    v_mfma_f32_32x32x16_bf16 v[52:67], v[96:99], v[40:43], v[52:67]
    ds_read_b128 v[40:43], v20 offset:32768
    s_waitcnt lgkmcnt(3)
    v_mfma_f32_32x32x16_bf16 v[52:67], v[100:103], v[28:31], v[52:67]
    ds_read_b128 v[28:31], v13 offset:33024
    s_waitcnt lgkmcnt(3)
    v_mfma_f32_32x32x16_bf16 v[52:67], v[104:107], v[32:35], v[52:67]
    ds_read_b128 v[32:35], v14 offset:33024
    s_waitcnt lgkmcnt(3)
    v_mfma_f32_32x32x16_bf16 v[52:67], v[108:111], v[36:39], v[52:67]
    ds_read_b128 v[36:39], v15 offset:33024
    s_waitcnt lgkmcnt(3)
    v_mfma_f32_32x32x16_bf16 v[52:67], v[112:115], v[40:43], v[52:67]
    ds_read_b128 v[40:43], v16 offset:33024
    s_waitcnt lgkmcnt(3)
    v_mfma_f32_32x32x16_bf16 v[52:67], v[116:119], v[28:31], v[52:67]
    ds_read_b128 v[28:31], v17 offset:33024
    s_waitcnt lgkmcnt(3)
    v_mfma_f32_32x32x16_bf16 v[52:67], v[120:123], v[32:35], v[52:67]
    ds_read_b128 v[32:35], v18 offset:33024
    s_waitcnt lgkmcnt(3)
    v_mfma_f32_32x32x16_bf16 v[52:67], v[124:127], v[36:39], v[52:67]
    ds_read_b128 v[36:39], v19 offset:33024
    s_waitcnt lgkmcnt(3)
    v_mfma_f32_32x32x16_bf16 v[52:67], v[128:131], v[40:43], v[52:67]
    ds_read_b128 v[40:43], v20 offset:33024
    s_waitcnt lgkmcnt(3)
    v_mfma_f32_32x32x16_bf16 v[52:67], v[132:135], v[28:31], v[52:67]
    ds_read_b128 v[28:31], v13 offset:33280
    s_waitcnt lgkmcnt(3)
    v_mfma_f32_32x32x16_bf16 v[52:67], v[136:139], v[32:35], v[52:67]
    ds_read_b128 v[32:35], v14 offset:33280
    s_waitcnt lgkmcnt(3)
    v_mfma_f32_32x32x16_bf16 v[52:67], v[140:143], v[36:39], v[52:67]
    ds_read_b128 v[36:39], v15 offset:33280
    s_waitcnt lgkmcnt(3)
    v_mfma_f32_32x32x16_bf16 v[52:67], v[144:147], v[40:43], v[52:67]
    ds_read_b128 v[40:43], v16 offset:33280
    s_waitcnt lgkmcnt(3)
    v_mfma_f32_32x32x16_bf16 v[52:67], v[148:151], v[28:31], v[52:67]
    ds_read_b128 v[28:31], v17 offset:33280
    s_waitcnt lgkmcnt(3)
    v_mfma_f32_32x32x16_bf16 v[52:67], v[152:155], v[32:35], v[52:67]
    ds_read_b128 v[32:35], v18 offset:33280
    s_waitcnt lgkmcnt(3)
    v_mfma_f32_32x32x16_bf16 v[52:67], v[156:159], v[36:39], v[52:67]
    ds_read_b128 v[36:39], v19 offset:33280
    s_waitcnt lgkmcnt(3)
    v_mfma_f32_32x32x16_bf16 v[52:67], v[160:163], v[40:43], v[52:67]
    ds_read_b128 v[40:43], v20 offset:33280
    s_waitcnt lgkmcnt(3)
    v_mfma_f32_32x32x16_bf16 v[52:67], v[164:167], v[28:31], v[52:67]
    ds_read_b128 v[28:31], v13 offset:33536
    s_waitcnt lgkmcnt(3)
    v_mfma_f32_32x32x16_bf16 v[52:67], v[168:171], v[32:35], v[52:67]
    ds_read_b128 v[32:35], v14 offset:33536
    s_waitcnt lgkmcnt(3)
    v_mfma_f32_32x32x16_bf16 v[52:67], v[172:175], v[36:39], v[52:67]
    ds_read_b128 v[36:39], v15 offset:33536
    s_waitcnt lgkmcnt(3)
    v_mfma_f32_32x32x16_bf16 v[52:67], v[176:179], v[40:43], v[52:67]
    ds_read_b128 v[40:43], v16 offset:33536
    s_waitcnt lgkmcnt(3)
    v_mfma_f32_32x32x16_bf16 v[52:67], v[180:183], v[28:31], v[52:67]
    ds_read_b128 v[28:31], v17 offset:33536
    s_waitcnt lgkmcnt(3)
    v_mfma_f32_32x32x16_bf16 v[52:67], v[184:187], v[32:35], v[52:67]
    ds_read_b128 v[32:35], v18 offset:33536
    s_waitcnt lgkmcnt(3)
    v_mfma_f32_32x32x16_bf16 v[52:67], v[188:191], v[36:39], v[52:67]
    ds_read_b128 v[36:39], v19 offset:33536
    s_waitcnt lgkmcnt(3)
    v_mfma_f32_32x32x16_bf16 v[52:67], v[192:195], v[40:43], v[52:67]
    ds_read_b128 v[40:43], v20 offset:33536
    s_waitcnt lgkmcnt(3)
    v_mfma_f32_32x32x16_bf16 v[52:67], v[196:199], v[28:31], v[52:67]
    s_waitcnt lgkmcnt(2)
    v_mfma_f32_32x32x16_bf16 v[52:67], v[200:203], v[32:35], v[52:67]
    s_waitcnt lgkmcnt(1)
    v_mfma_f32_32x32x16_bf16 v[52:67], v[204:207], v[36:39], v[52:67]
    s_waitcnt lgkmcnt(0)
    v_mfma_f32_32x32x16_bf16 v[52:67], v[208:211], v[40:43], v[52:67]
    s_nop 15
    v_cvt_pk_bf16_f32 v44, v52, v53
    v_cvt_pk_bf16_f32 v45, v54, v55
    v_cvt_pk_bf16_f32 v46, v56, v57
    v_cvt_pk_bf16_f32 v47, v58, v59
    buffer_store_dwordx4 v[44:47], v2, s[24:27], s46 offen sc0 sc1
    s_endpgm
L_proj_spN1:
    ds_read_b128 v[28:31], v13 offset:32768
    ds_read_b128 v[32:35], v14 offset:32768
    ds_read_b128 v[36:39], v15 offset:32768
    ds_read_b128 v[40:43], v16 offset:32768
    s_waitcnt lgkmcnt(3)
    v_mfma_f32_32x32x16_bf16 v[52:67], v[28:31], v[84:87], 0
    ds_read_b128 v[28:31], v17 offset:32768
    s_waitcnt lgkmcnt(3)
    v_mfma_f32_32x32x16_bf16 v[52:67], v[32:35], v[88:91], v[52:67]
    ds_read_b128 v[32:35], v18 offset:32768
    s_waitcnt lgkmcnt(3)
    v_mfma_f32_32x32x16_bf16 v[52:67], v[36:39], v[92:95], v[52:67]
    ds_read_b128 v[36:39], v19 offset:32768
    s_waitcnt lgkmcnt(3)
    v_mfma_f32_32x32x16_bf16 v[52:67], v[40:43], v[96:99], v[52:67]
    ds_read_b128 v[40:43], v20 offset:32768
    s_waitcnt lgkmcnt(3)
    v_mfma_f32_32x32x16_bf16 v[52:67], v[28:31], v[100:103], v[52:67]
    ds_read_b128 v[28:31], v13 offset:33024
    s_waitcnt lgkmcnt(3)
    v_mfma_f32_32x32x16_bf16 v[52:67], v[32:35], v[104:107], v[52:67]
    ds_read_b128 v[32:35], v14 offset:33024
    s_waitcnt lgkmcnt(3)
    v_mfma_f32_32x32x16_bf16 v[52:67], v[36:39], v[108:111], v[52:67]
    ds_read_b128 v[36:39], v15 offset:33024
    s_waitcnt lgkmcnt(3)
    v_mfma_f32_32x32x16_bf16 v[52:67], v[40:43], v[112:115], v[52:67]
    ds_read_b128 v[40:43], v16 offset:33024
    s_waitcnt lgkmcnt(3)
    v_mfma_f32_32x32x16_bf16 v[52:67], v[28:31], v[116:119], v[52:67]
    ds_read_b128 v[28:31], v17 offset:33024
    s_waitcnt lgkmcnt(3)
    v_mfma_f32_32x32x16_bf16 v[52:67], v[32:35], v[120:123], v[52:67]
    ds_read_b128 v[32:35], v18 offset:33024
    s_waitcnt lgkmcnt(3)
    v_mfma_f32_32x32x16_bf16 v[52:67], v[36:39], v[124:127], v[52:67]
    ds_read_b128 v[36:39], v19 offset:33024
    s_waitcnt lgkmcnt(3)
    v_mfma_f32_32x32x16_bf16 v[52:67], v[40:43], v[128:131], v[52:67]
    ds_read_b128 v[40:43], v20 offset:33024
    s_waitcnt lgkmcnt(3)
    v_mfma_f32_32x32x16_bf16 v[52:67], v[28:31], v[132:135], v[52:67]
    ds_read_b128 v[28:31], v13 offset:33280
    s_waitcnt lgkmcnt(3)
    v_mfma_f32_32x32x16_bf16 v[52:67], v[32:35], v[136:139], v[52:67]
    ds_read_b128 v[32:35], v14 offset:33280
    s_waitcnt lgkmcnt(3)
    v_mfma_f32_32x32x16_bf16 v[52:67], v[36:39], v[140:143], v[52:67]
    ds_read_b128 v[36:39], v15 offset:33280
    s_waitcnt lgkmcnt(3)
    v_mfma_f32_32x32x16_bf16 v[52:67], v[40:43], v[144:147], v[52:67]
    ds_read_b128 v[40:43], v16 offset:33280
    s_waitcnt lgkmcnt(3)
    v_mfma_f32_32x32x16_bf16 v[52:67], v[28:31], v[148:151], v[52:67]
    ds_read_b128 v[28:31], v17 offset:33280
    s_waitcnt lgkmcnt(3)
    v_mfma_f32_32x32x16_bf16 v[52:67], v[32:35], v[152:155], v[52:67]
    ds_read_b128 v[32:35], v18 offset:33280
    s_waitcnt lgkmcnt(3)
    v_mfma_f32_32x32x16_bf16 v[52:67], v[36:39], v[156:159], v[52:67]
    ds_read_b128 v[36:39], v19 offset:33280
    s_waitcnt lgkmcnt(3)
    v_mfma_f32_32x32x16_bf16 v[52:67], v[40:43], v[160:163], v[52:67]
    ds_read_b128 v[40:43], v20 offset:33280
    s_waitcnt lgkmcnt(3)
    v_mfma_f32_32x32x16_bf16 v[52:67], v[28:31], v[164:167], v[52:67]
    ds_read_b128 v[28:31], v13 offset:33536
    s_waitcnt lgkmcnt(3)
    v_mfma_f32_32x32x16_bf16 v[52:67], v[32:35], v[168:171], v[52:67]
    ds_read_b128 v[32:35], v14 offset:33536
    s_waitcnt lgkmcnt(3)
    v_mfma_f32_32x32x16_bf16 v[52:67], v[36:39], v[172:175], v[52:67]
    ds_read_b128 v[36:39], v15 offset:33536
    s_waitcnt lgkmcnt(3)
    v_mfma_f32_32x32x16_bf16 v[52:67], v[40:43], v[176:179], v[52:67]
    ds_read_b128 v[40:43], v16 offset:33536
    s_waitcnt lgkmcnt(3)
    v_mfma_f32_32x32x16_bf16 v[52:67], v[28:31], v[180:183], v[52:67]
    ds_read_b128 v[28:31], v17 offset:33536
    s_waitcnt lgkmcnt(3)
    v_mfma_f32_32x32x16_bf16 v[52:67], v[32:35], v[184:187], v[52:67]
    ds_read_b128 v[32:35], v18 offset:33536
    s_waitcnt lgkmcnt(3)
    v_mfma_f32_32x32x16_bf16 v[52:67], v[36:39], v[188:191], v[52:67]
    ds_read_b128 v[36:39], v19 offset:33536
    s_waitcnt lgkmcnt(3)
    v_mfma_f32_32x32x16_bf16 v[52:67], v[40:43], v[192:195], v[52:67]
    ds_read_b128 v[40:43], v20 offset:33536
    s_waitcnt lgkmcnt(3)
    v_mfma_f32_32x32x16_bf16 v[52:67], v[28:31], v[196:199], v[52:67]
    s_waitcnt lgkmcnt(2)
    v_mfma_f32_32x32x16_bf16 v[52:67], v[32:35], v[200:203], v[52:67]
    s_waitcnt lgkmcnt(1)
    v_mfma_f32_32x32x16_bf16 v[52:67], v[36:39], v[204:207], v[52:67]
    s_waitcnt lgkmcnt(0)
    v_mfma_f32_32x32x16_bf16 v[52:67], v[40:43], v[208:211], v[52:67]
    s_nop 15
    v_cvt_pk_bf16_f32 v44, v52, v53
    v_cvt_pk_bf16_f32 v45, v54, v55
    v_cvt_pk_bf16_f32 v46, v56, v57
    v_cvt_pk_bf16_f32 v47, v58, v59
    v_cvt_pk_bf16_f32 v48, v60, v61
    v_cvt_pk_bf16_f32 v49, v62, v63
    v_cvt_pk_bf16_f32 v50, v64, v65
    v_cvt_pk_bf16_f32 v51, v66, v67
    buffer_store_dwordx4 v[44:47], v25, s[24:27], s46 offen offset:1024 sc0 sc1
    buffer_store_dwordx4 v[48:51], v25, s[24:27], s46 offen offset:1280 sc0 sc1
    s_endpgm
L_proj_sp2:
    s_cmp_lg_u32 s38, 2
    s_cbranch_scc1 L_proj_sp3
    s_barrier
    s_cmp_ge_u32 s33, 4
    s_cbranch_scc1 L_proj_spN2
    ds_read_b128 v[28:31], v5 offset:0
    ds_read_b128 v[32:35], v6 offset:0
    ds_read_b128 v[36:39], v7 offset:0
    ds_read_b128 v[40:43], v8 offset:0
    s_waitcnt lgkmcnt(3)
    v_mfma_f32_32x32x16_bf16 v[52:67], v[84:87], v[28:31], 0
    ds_read_b128 v[28:31], v9 offset:0
    s_waitcnt lgkmcnt(3)
    v_mfma_f32_32x32x16_bf16 v[52:67], v[88:91], v[32:35], v[52:67]
    ds_read_b128 v[32:35], v10 offset:0
    s_waitcnt lgkmcnt(3)
    v_mfma_f32_32x32x16_bf16 v[52:67], v[92:95], v[36:39], v[52:67]
    ds_read_b128 v[36:39], v11 offset:0
    s_waitcnt lgkmcnt(3)
    v_mfma_f32_32x32x16_bf16 v[52:67], v[96:99], v[40:43], v[52:67]
    ds_read_b128 v[40:43], v12 offset:0
    s_waitcnt lgkmcnt(3)
    v_mfma_f32_32x32x16_bf16 v[52:67], v[100:103], v[28:31], v[52:67]
    ds_read_b128 v[28:31], v5 offset:256
    s_waitcnt lgkmcnt(3)
    v_mfma_f32_32x32x16_bf16 v[52:67], v[104:107], v[32:35], v[52:67]
    ds_read_b128 v[32:35], v6 offset:256
    s_waitcnt lgkmcnt(3)
    v_mfma_f32_32x32x16_bf16 v[52:67], v[108:111], v[36:39], v[52:67]
    ds_read_b128 v[36:39], v7 offset:256
    s_waitcnt lgkmcnt(3)
    v_mfma_f32_32x32x16_bf16 v[52:67], v[112:115], v[40:43], v[52:67]
    ds_read_b128 v[40:43], v8 offset:256
    s_waitcnt lgkmcnt(3)
    v_mfma_f32_32x32x16_bf16 v[52:67], v[116:119], v[28:31], v[52:67]
    ds_read_b128 v[28:31], v9 offset:256
    s_waitcnt lgkmcnt(3)
    v_mfma_f32_32x32x16_bf16 v[52:67], v[120:123], v[32:35], v[52:67]
    ds_read_b128 v[32:35], v10 offset:256
    s_waitcnt lgkmcnt(3)
    v_mfma_f32_32x32x16_bf16 v[52:67], v[124:127], v[36:39], v[52:67]
    ds_read_b128 v[36:39], v11 offset:256
    s_waitcnt lgkmcnt(3)
    v_mfma_f32_32x32x16_bf16 v[52:67], v[128:131], v[40:43], v[52:67]
    ds_read_b128 v[40:43], v12 offset:256
    s_waitcnt lgkmcnt(3)
    v_mfma_f32_32x32x16_bf16 v[52:67], v[132:135], v[28:31], v[52:67]
    ds_read_b128 v[28:31], v5 offset:512
    s_waitcnt lgkmcnt(3)
    v_mfma_f32_32x32x16_bf16 v[52:67], v[136:139], v[32:35], v[52:67]
    ds_read_b128 v[32:35], v6 offset:512
    s_waitcnt lgkmcnt(3)
    v_mfma_f32_32x32x16_bf16 v[52:67], v[140:143], v[36:39], v[52:67]
    ds_read_b128 v[36:39], v7 offset:512
    s_waitcnt lgkmcnt(3)
    v_mfma_f32_32x32x16_bf16 v[52:67], v[144:147], v[40:43], v[52:67]
    ds_read_b128 v[40:43], v8 offset:512
    s_waitcnt lgkmcnt(3)
    v_mfma_f32_32x32x16_bf16 v[52:67], v[148:151], v[28:31], v[52:67]
    ds_read_b128 v[28:31], v9 offset:512
    s_waitcnt lgkmcnt(3)
    v_mfma_f32_32x32x16_bf16 v[52:67], v[152:155], v[32:35], v[52:67]
    ds_read_b128 v[32:35], v10 offset:512
    s_waitcnt lgkmcnt(3)
    v_mfma_f32_32x32x16_bf16 v[52:67], v[156:159], v[36:39], v[52:67]
    ds_read_b128 v[36:39], v11 offset:512
    s_waitcnt lgkmcnt(3)
    v_mfma_f32_32x32x16_bf16 v[52:67], v[160:163], v[40:43], v[52:67]
    ds_read_b128 v[40:43], v12 offset:512
    s_waitcnt lgkmcnt(3)
    v_mfma_f32_32x32x16_bf16 v[52:67], v[164:167], v[28:31], v[52:67]
    ds_read_b128 v[28:31], v5 offset:768
    s_waitcnt lgkmcnt(3)
    v_mfma_f32_32x32x16_bf16 v[52:67], v[168:171], v[32:35], v[52:67]
    ds_read_b128 v[32:35], v6 offset:768
    s_waitcnt lgkmcnt(3)
    v_mfma_f32_32x32x16_bf16 v[52:67], v[172:175], v[36:39], v[52:67]
    ds_read_b128 v[36:39], v7 offset:768
    s_waitcnt lgkmcnt(3)
    v_mfma_f32_32x32x16_bf16 v[52:67], v[176:179], v[40:43], v[52:67]
    ds_read_b128 v[40:43], v8 offset:768
    s_waitcnt lgkmcnt(3)
    v_mfma_f32_32x32x16_bf16 v[52:67], v[180:183], v[28:31], v[52:67]
    ds_read_b128 v[28:31], v9 offset:768
    s_waitcnt lgkmcnt(3)
    v_mfma_f32_32x32x16_bf16 v[52:67], v[184:187], v[32:35], v[52:67]
    ds_read_b128 v[32:35], v10 offset:768
    s_waitcnt lgkmcnt(3)
    v_mfma_f32_32x32x16_bf16 v[52:67], v[188:191], v[36:39], v[52:67]
    ds_read_b128 v[36:39], v11 offset:768
    s_waitcnt lgkmcnt(3)
    v_mfma_f32_32x32x16_bf16 v[52:67], v[192:195], v[40:43], v[52:67]
    ds_read_b128 v[40:43], v12 offset:768
    s_waitcnt lgkmcnt(3)
    v_mfma_f32_32x32x16_bf16 v[52:67], v[196:199], v[28:31], v[52:67]
    s_waitcnt lgkmcnt(2)
    v_mfma_f32_32x32x16_bf16 v[52:67], v[200:203], v[32:35], v[52:67]
    s_waitcnt lgkmcnt(1)
    v_mfma_f32_32x32x16_bf16 v[52:67], v[204:207], v[36:39], v[52:67]
    s_waitcnt lgkmcnt(0)
    v_mfma_f32_32x32x16_bf16 v[52:67], v[208:211], v[40:43], v[52:67]
    s_nop 15
    v_cvt_pk_bf16_f32 v44, v52, v53
    v_cvt_pk_bf16_f32 v45, v54, v55
    v_cvt_pk_bf16_f32 v46, v56, v57
    v_cvt_pk_bf16_f32 v47, v58, v59
    buffer_store_dwordx4 v[44:47], v2, s[24:27], s46 offen sc0 sc1
    s_endpgm
L_proj_spN2:
    ds_read_b128 v[28:31], v5 offset:0
    ds_read_b128 v[32:35], v6 offset:0
    ds_read_b128 v[36:39], v7 offset:0
    ds_read_b128 v[40:43], v8 offset:0
    s_waitcnt lgkmcnt(3)
    v_mfma_f32_32x32x16_bf16 v[52:67], v[28:31], v[84:87], 0
    ds_read_b128 v[28:31], v9 offset:0
    s_waitcnt lgkmcnt(3)
    v_mfma_f32_32x32x16_bf16 v[52:67], v[32:35], v[88:91], v[52:67]
    ds_read_b128 v[32:35], v10 offset:0
    s_waitcnt lgkmcnt(3)
    v_mfma_f32_32x32x16_bf16 v[52:67], v[36:39], v[92:95], v[52:67]
    ds_read_b128 v[36:39], v11 offset:0
    s_waitcnt lgkmcnt(3)
    v_mfma_f32_32x32x16_bf16 v[52:67], v[40:43], v[96:99], v[52:67]
    ds_read_b128 v[40:43], v12 offset:0
    s_waitcnt lgkmcnt(3)
    v_mfma_f32_32x32x16_bf16 v[52:67], v[28:31], v[100:103], v[52:67]
    ds_read_b128 v[28:31], v5 offset:256
    s_waitcnt lgkmcnt(3)
    v_mfma_f32_32x32x16_bf16 v[52:67], v[32:35], v[104:107], v[52:67]
    ds_read_b128 v[32:35], v6 offset:256
    s_waitcnt lgkmcnt(3)
    v_mfma_f32_32x32x16_bf16 v[52:67], v[36:39], v[108:111], v[52:67]
    ds_read_b128 v[36:39], v7 offset:256
    s_waitcnt lgkmcnt(3)
    v_mfma_f32_32x32x16_bf16 v[52:67], v[40:43], v[112:115], v[52:67]
    ds_read_b128 v[40:43], v8 offset:256
    s_waitcnt lgkmcnt(3)
    v_mfma_f32_32x32x16_bf16 v[52:67], v[28:31], v[116:119], v[52:67]
    ds_read_b128 v[28:31], v9 offset:256
    s_waitcnt lgkmcnt(3)
    v_mfma_f32_32x32x16_bf16 v[52:67], v[32:35], v[120:123], v[52:67]
    ds_read_b128 v[32:35], v10 offset:256
    s_waitcnt lgkmcnt(3)
    v_mfma_f32_32x32x16_bf16 v[52:67], v[36:39], v[124:127], v[52:67]
    ds_read_b128 v[36:39], v11 offset:256
    s_waitcnt lgkmcnt(3)
    v_mfma_f32_32x32x16_bf16 v[52:67], v[40:43], v[128:131], v[52:67]
    ds_read_b128 v[40:43], v12 offset:256
    s_waitcnt lgkmcnt(3)
    v_mfma_f32_32x32x16_bf16 v[52:67], v[28:31], v[132:135], v[52:67]
    ds_read_b128 v[28:31], v5 offset:512
    s_waitcnt lgkmcnt(3)
    v_mfma_f32_32x32x16_bf16 v[52:67], v[32:35], v[136:139], v[52:67]
    ds_read_b128 v[32:35], v6 offset:512
    s_waitcnt lgkmcnt(3)
    v_mfma_f32_32x32x16_bf16 v[52:67], v[36:39], v[140:143], v[52:67]
    ds_read_b128 v[36:39], v7 offset:512
    s_waitcnt lgkmcnt(3)
    v_mfma_f32_32x32x16_bf16 v[52:67], v[40:43], v[144:147], v[52:67]
    ds_read_b128 v[40:43], v8 offset:512
    s_waitcnt lgkmcnt(3)
    v_mfma_f32_32x32x16_bf16 v[52:67], v[28:31], v[148:151], v[52:67]
    ds_read_b128 v[28:31], v9 offset:512
    s_waitcnt lgkmcnt(3)
    v_mfma_f32_32x32x16_bf16 v[52:67], v[32:35], v[152:155], v[52:67]
    ds_read_b128 v[32:35], v10 offset:512
    s_waitcnt lgkmcnt(3)
    v_mfma_f32_32x32x16_bf16 v[52:67], v[36:39], v[156:159], v[52:67]
    ds_read_b128 v[36:39], v11 offset:512
    s_waitcnt lgkmcnt(3)
    v_mfma_f32_32x32x16_bf16 v[52:67], v[40:43], v[160:163], v[52:67]
    ds_read_b128 v[40:43], v12 offset:512
    s_waitcnt lgkmcnt(3)
    v_mfma_f32_32x32x16_bf16 v[52:67], v[28:31], v[164:167], v[52:67]
    ds_read_b128 v[28:31], v5 offset:768
    s_waitcnt lgkmcnt(3)
    v_mfma_f32_32x32x16_bf16 v[52:67], v[32:35], v[168:171], v[52:67]
    ds_read_b128 v[32:35], v6 offset:768
    s_waitcnt lgkmcnt(3)
    v_mfma_f32_32x32x16_bf16 v[52:67], v[36:39], v[172:175], v[52:67]
    ds_read_b128 v[36:39], v7 offset:768
    s_waitcnt lgkmcnt(3)
    v_mfma_f32_32x32x16_bf16 v[52:67], v[40:43], v[176:179], v[52:67]
    ds_read_b128 v[40:43], v8 offset:768
    s_waitcnt lgkmcnt(3)
    v_mfma_f32_32x32x16_bf16 v[52:67], v[28:31], v[180:183], v[52:67]
    ds_read_b128 v[28:31], v9 offset:768
    s_waitcnt lgkmcnt(3)
    v_mfma_f32_32x32x16_bf16 v[52:67], v[32:35], v[184:187], v[52:67]
    ds_read_b128 v[32:35], v10 offset:768
    s_waitcnt lgkmcnt(3)
    v_mfma_f32_32x32x16_bf16 v[52:67], v[36:39], v[188:191], v[52:67]
    ds_read_b128 v[36:39], v11 offset:768
    s_waitcnt lgkmcnt(3)
    v_mfma_f32_32x32x16_bf16 v[52:67], v[40:43], v[192:195], v[52:67]
    ds_read_b128 v[40:43], v12 offset:768
    s_waitcnt lgkmcnt(3)
    v_mfma_f32_32x32x16_bf16 v[52:67], v[28:31], v[196:199], v[52:67]
    s_waitcnt lgkmcnt(2)
    v_mfma_f32_32x32x16_bf16 v[52:67], v[32:35], v[200:203], v[52:67]
    s_waitcnt lgkmcnt(1)
    v_mfma_f32_32x32x16_bf16 v[52:67], v[36:39], v[204:207], v[52:67]
    s_waitcnt lgkmcnt(0)
    v_mfma_f32_32x32x16_bf16 v[52:67], v[40:43], v[208:211], v[52:67]
    s_nop 15
    v_cvt_pk_bf16_f32 v44, v52, v53
    v_cvt_pk_bf16_f32 v45, v54, v55
    v_cvt_pk_bf16_f32 v46, v56, v57
    v_cvt_pk_bf16_f32 v47, v58, v59
    v_cvt_pk_bf16_f32 v48, v60, v61
    v_cvt_pk_bf16_f32 v49, v62, v63
    v_cvt_pk_bf16_f32 v50, v64, v65
    v_cvt_pk_bf16_f32 v51, v66, v67
    buffer_store_dwordx4 v[44:47], v25, s[24:27], s46 offen offset:1024 sc0 sc1
    buffer_store_dwordx4 v[48:51], v25, s[24:27], s46 offen offset:1280 sc0 sc1
    s_endpgm
L_proj_sp3:
    s_cmp_lg_u32 s38, 3
    s_cbranch_scc1 L_proj_sp4
    s_barrier
    s_barrier
    s_cmp_ge_u32 s33, 4
    s_cbranch_scc1 L_proj_spN3
    ds_read_b128 v[28:31], v5 offset:32768
    ds_read_b128 v[32:35], v6 offset:32768
    ds_read_b128 v[36:39], v7 offset:32768
    ds_read_b128 v[40:43], v8 offset:32768
    s_waitcnt lgkmcnt(3)
    v_mfma_f32_32x32x16_bf16 v[52:67], v[84:87], v[28:31], 0
    ds_read_b128 v[28:31], v9 offset:32768
    s_waitcnt lgkmcnt(3)
    v_mfma_f32_32x32x16_bf16 v[52:67], v[88:91], v[32:35], v[52:67]
    ds_read_b128 v[32:35], v10 offset:32768
    s_waitcnt lgkmcnt(3)
    v_mfma_f32_32x32x16_bf16 v[52:67], v[92:95], v[36:39], v[52:67]
    ds_read_b128 v[36:39], v11 offset:32768
    s_waitcnt lgkmcnt(3)
    v_mfma_f32_32x32x16_bf16 v[52:67], v[96:99], v[40:43], v[52:67]
    ds_read_b128 v[40:43], v12 offset:32768
    s_waitcnt lgkmcnt(3)
    v_mfma_f32_32x32x16_bf16 v[52:67], v[100:103], v[28:31], v[52:67]
    ds_read_b128 v[28:31], v5 offset:33024
    s_waitcnt lgkmcnt(3)
    v_mfma_f32_32x32x16_bf16 v[52:67], v[104:107], v[32:35], v[52:67]
    ds_read_b128 v[32:35], v6 offset:33024
    s_waitcnt lgkmcnt(3)
    v_mfma_f32_32x32x16_bf16 v[52:67], v[108:111], v[36:39], v[52:67]
    ds_read_b128 v[36:39], v7 offset:33024
    s_waitcnt lgkmcnt(3)
    v_mfma_f32_32x32x16_bf16 v[52:67], v[112:115], v[40:43], v[52:67]
    ds_read_b128 v[40:43], v8 offset:33024
    s_waitcnt lgkmcnt(3)
    v_mfma_f32_32x32x16_bf16 v[52:67], v[116:119], v[28:31], v[52:67]
    ds_read_b128 v[28:31], v9 offset:33024
    s_waitcnt lgkmcnt(3)
    v_mfma_f32_32x32x16_bf16 v[52:67], v[120:123], v[32:35], v[52:67]
    ds_read_b128 v[32:35], v10 offset:33024
    s_waitcnt lgkmcnt(3)
    v_mfma_f32_32x32x16_bf16 v[52:67], v[124:127], v[36:39], v[52:67]
    ds_read_b128 v[36:39], v11 offset:33024
    s_waitcnt lgkmcnt(3)
    v_mfma_f32_32x32x16_bf16 v[52:67], v[128:131], v[40:43], v[52:67]
    ds_read_b128 v[40:43], v12 offset:33024
    s_waitcnt lgkmcnt(3)
    v_mfma_f32_32x32x16_bf16 v[52:67], v[132:135], v[28:31], v[52:67]
    ds_read_b128 v[28:31], v5 offset:33280
    s_waitcnt lgkmcnt(3)
    v_mfma_f32_32x32x16_bf16 v[52:67], v[136:139], v[32:35], v[52:67]
    ds_read_b128 v[32:35], v6 offset:33280
    s_waitcnt lgkmcnt(3)
    v_mfma_f32_32x32x16_bf16 v[52:67], v[140:143], v[36:39], v[52:67]
    ds_read_b128 v[36:39], v7 offset:33280
    s_waitcnt lgkmcnt(3)
    v_mfma_f32_32x32x16_bf16 v[52:67], v[144:147], v[40:43], v[52:67]
    ds_read_b128 v[40:43], v8 offset:33280
    s_waitcnt lgkmcnt(3)
    v_mfma_f32_32x32x16_bf16 v[52:67], v[148:151], v[28:31], v[52:67]
    ds_read_b128 v[28:31], v9 offset:33280
    s_waitcnt lgkmcnt(3)
    v_mfma_f32_32x32x16_bf16 v[52:67], v[152:155], v[32:35], v[52:67]
    ds_read_b128 v[32:35], v10 offset:33280
    s_waitcnt lgkmcnt(3)
    v_mfma_f32_32x32x16_bf16 v[52:67], v[156:159], v[36:39], v[52:67]
    ds_read_b128 v[36:39], v11 offset:33280
    s_waitcnt lgkmcnt(3)
    v_mfma_f32_32x32x16_bf16 v[52:67], v[160:163], v[40:43], v[52:67]
    ds_read_b128 v[40:43], v12 offset:33280
    s_waitcnt lgkmcnt(3)
    v_mfma_f32_32x32x16_bf16 v[52:67], v[164:167], v[28:31], v[52:67]
    ds_read_b128 v[28:31], v5 offset:33536
    s_waitcnt lgkmcnt(3)
    v_mfma_f32_32x32x16_bf16 v[52:67], v[168:171], v[32:35], v[52:67]
    ds_read_b128 v[32:35], v6 offset:33536
    s_waitcnt lgkmcnt(3)
    v_mfma_f32_32x32x16_bf16 v[52:67], v[172:175], v[36:39], v[52:67]
    ds_read_b128 v[36:39], v7 offset:33536
    s_waitcnt lgkmcnt(3)
    v_mfma_f32_32x32x16_bf16 v[52:67], v[176:179], v[40:43], v[52:67]
    ds_read_b128 v[40:43], v8 offset:33536
    s_waitcnt lgkmcnt(3)
    v_mfma_f32_32x32x16_bf16 v[52:67], v[180:183], v[28:31], v[52:67]
    ds_read_b128 v[28:31], v9 offset:33536
    s_waitcnt lgkmcnt(3)
    v_mfma_f32_32x32x16_bf16 v[52:67], v[184:187], v[32:35], v[52:67]
    ds_read_b128 v[32:35], v10 offset:33536
    s_waitcnt lgkmcnt(3)
    v_mfma_f32_32x32x16_bf16 v[52:67], v[188:191], v[36:39], v[52:67]
    ds_read_b128 v[36:39], v11 offset:33536
    s_waitcnt lgkmcnt(3)
    v_mfma_f32_32x32x16_bf16 v[52:67], v[192:195], v[40:43], v[52:67]
    ds_read_b128 v[40:43], v12 offset:33536
    s_waitcnt lgkmcnt(3)
    v_mfma_f32_32x32x16_bf16 v[52:67], v[196:199], v[28:31], v[52:67]
    s_waitcnt lgkmcnt(2)
    v_mfma_f32_32x32x16_bf16 v[52:67], v[200:203], v[32:35], v[52:67]
    s_waitcnt lgkmcnt(1)
    v_mfma_f32_32x32x16_bf16 v[52:67], v[204:207], v[36:39], v[52:67]
    s_waitcnt lgkmcnt(0)
    v_mfma_f32_32x32x16_bf16 v[52:67], v[208:211], v[40:43], v[52:67]
    s_nop 15
    v_cvt_pk_bf16_f32 v44, v52, v53
    v_cvt_pk_bf16_f32 v45, v54, v55
    v_cvt_pk_bf16_f32 v46, v56, v57
    v_cvt_pk_bf16_f32 v47, v58, v59
    buffer_store_dwordx4 v[44:47], v2, s[24:27], s46 offen sc0 sc1
    s_endpgm
L_proj_spN3:
    ds_read_b128 v[28:31], v5 offset:32768
    ds_read_b128 v[32:35], v6 offset:32768
    ds_read_b128 v[36:39], v7 offset:32768
    ds_read_b128 v[40:43], v8 offset:32768
    s_waitcnt lgkmcnt(3)
    v_mfma_f32_32x32x16_bf16 v[52:67], v[28:31], v[84:87], 0
    ds_read_b128 v[28:31], v9 offset:32768
    s_waitcnt lgkmcnt(3)
    v_mfma_f32_32x32x16_bf16 v[52:67], v[32:35], v[88:91], v[52:67]
    ds_read_b128 v[32:35], v10 offset:32768
    s_waitcnt lgkmcnt(3)
    v_mfma_f32_32x32x16_bf16 v[52:67], v[36:39], v[92:95], v[52:67]
    ds_read_b128 v[36:39], v11 offset:32768
    s_waitcnt lgkmcnt(3)
    v_mfma_f32_32x32x16_bf16 v[52:67], v[40:43], v[96:99], v[52:67]
    ds_read_b128 v[40:43], v12 offset:32768
    s_waitcnt lgkmcnt(3)
    v_mfma_f32_32x32x16_bf16 v[52:67], v[28:31], v[100:103], v[52:67]
    ds_read_b128 v[28:31], v5 offset:33024
    s_waitcnt lgkmcnt(3)
    v_mfma_f32_32x32x16_bf16 v[52:67], v[32:35], v[104:107], v[52:67]
    ds_read_b128 v[32:35], v6 offset:33024
    s_waitcnt lgkmcnt(3)
    v_mfma_f32_32x32x16_bf16 v[52:67], v[36:39], v[108:111], v[52:67]
    ds_read_b128 v[36:39], v7 offset:33024
    s_waitcnt lgkmcnt(3)
    v_mfma_f32_32x32x16_bf16 v[52:67], v[40:43], v[112:115], v[52:67]
    ds_read_b128 v[40:43], v8 offset:33024
    s_waitcnt lgkmcnt(3)
    v_mfma_f32_32x32x16_bf16 v[52:67], v[28:31], v[116:119], v[52:67]
    ds_read_b128 v[28:31], v9 offset:33024
    s_waitcnt lgkmcnt(3)
    v_mfma_f32_32x32x16_bf16 v[52:67], v[32:35], v[120:123], v[52:67]
    ds_read_b128 v[32:35], v10 offset:33024
    s_waitcnt lgkmcnt(3)
    v_mfma_f32_32x32x16_bf16 v[52:67], v[36:39], v[124:127], v[52:67]
    ds_read_b128 v[36:39], v11 offset:33024
    s_waitcnt lgkmcnt(3)
    v_mfma_f32_32x32x16_bf16 v[52:67], v[40:43], v[128:131], v[52:67]
    ds_read_b128 v[40:43], v12 offset:33024
    s_waitcnt lgkmcnt(3)
    v_mfma_f32_32x32x16_bf16 v[52:67], v[28:31], v[132:135], v[52:67]
    ds_read_b128 v[28:31], v5 offset:33280
    s_waitcnt lgkmcnt(3)
    v_mfma_f32_32x32x16_bf16 v[52:67], v[32:35], v[136:139], v[52:67]
    ds_read_b128 v[32:35], v6 offset:33280
    s_waitcnt lgkmcnt(3)
    v_mfma_f32_32x32x16_bf16 v[52:67], v[36:39], v[140:143], v[52:67]
    ds_read_b128 v[36:39], v7 offset:33280
    s_waitcnt lgkmcnt(3)
    v_mfma_f32_32x32x16_bf16 v[52:67], v[40:43], v[144:147], v[52:67]
    ds_read_b128 v[40:43], v8 offset:33280
    s_waitcnt lgkmcnt(3)
    v_mfma_f32_32x32x16_bf16 v[52:67], v[28:31], v[148:151], v[52:67]
    ds_read_b128 v[28:31], v9 offset:33280
    s_waitcnt lgkmcnt(3)
    v_mfma_f32_32x32x16_bf16 v[52:67], v[32:35], v[152:155], v[52:67]
    ds_read_b128 v[32:35], v10 offset:33280
    s_waitcnt lgkmcnt(3)
    v_mfma_f32_32x32x16_bf16 v[52:67], v[36:39], v[156:159], v[52:67]
    ds_read_b128 v[36:39], v11 offset:33280
    s_waitcnt lgkmcnt(3)
    v_mfma_f32_32x32x16_bf16 v[52:67], v[40:43], v[160:163], v[52:67]
    ds_read_b128 v[40:43], v12 offset:33280
    s_waitcnt lgkmcnt(3)
    v_mfma_f32_32x32x16_bf16 v[52:67], v[28:31], v[164:167], v[52:67]
    ds_read_b128 v[28:31], v5 offset:33536
    s_waitcnt lgkmcnt(3)
    v_mfma_f32_32x32x16_bf16 v[52:67], v[32:35], v[168:171], v[52:67]
    ds_read_b128 v[32:35], v6 offset:33536
    s_waitcnt lgkmcnt(3)
    v_mfma_f32_32x32x16_bf16 v[52:67], v[36:39], v[172:175], v[52:67]
    ds_read_b128 v[36:39], v7 offset:33536
    s_waitcnt lgkmcnt(3)
    v_mfma_f32_32x32x16_bf16 v[52:67], v[40:43], v[176:179], v[52:67]
    ds_read_b128 v[40:43], v8 offset:33536
    s_waitcnt lgkmcnt(3)
    v_mfma_f32_32x32x16_bf16 v[52:67], v[28:31], v[180:183], v[52:67]
    ds_read_b128 v[28:31], v9 offset:33536
    s_waitcnt lgkmcnt(3)
    v_mfma_f32_32x32x16_bf16 v[52:67], v[32:35], v[184:187], v[52:67]
    ds_read_b128 v[32:35], v10 offset:33536
    s_waitcnt lgkmcnt(3)
    v_mfma_f32_32x32x16_bf16 v[52:67], v[36:39], v[188:191], v[52:67]
    ds_read_b128 v[36:39], v11 offset:33536
    s_waitcnt lgkmcnt(3)
    v_mfma_f32_32x32x16_bf16 v[52:67], v[40:43], v[192:195], v[52:67]
    ds_read_b128 v[40:43], v12 offset:33536
    s_waitcnt lgkmcnt(3)
    v_mfma_f32_32x32x16_bf16 v[52:67], v[28:31], v[196:199], v[52:67]
    s_waitcnt lgkmcnt(2)
    v_mfma_f32_32x32x16_bf16 v[52:67], v[32:35], v[200:203], v[52:67]
    s_waitcnt lgkmcnt(1)
    v_mfma_f32_32x32x16_bf16 v[52:67], v[36:39], v[204:207], v[52:67]
    s_waitcnt lgkmcnt(0)
    v_mfma_f32_32x32x16_bf16 v[52:67], v[40:43], v[208:211], v[52:67]
    s_nop 15
    v_cvt_pk_bf16_f32 v44, v52, v53
    v_cvt_pk_bf16_f32 v45, v54, v55
    v_cvt_pk_bf16_f32 v46, v56, v57
    v_cvt_pk_bf16_f32 v47, v58, v59
    v_cvt_pk_bf16_f32 v48, v60, v61
    v_cvt_pk_bf16_f32 v49, v62, v63
    v_cvt_pk_bf16_f32 v50, v64, v65
    v_cvt_pk_bf16_f32 v51, v66, v67
    buffer_store_dwordx4 v[44:47], v25, s[24:27], s46 offen offset:1024 sc0 sc1
    buffer_store_dwordx4 v[48:51], v25, s[24:27], s46 offen offset:1280 sc0 sc1
    s_endpgm
L_proj_sp4:
L_proj_end:
    s_endpgm
.text
.globl attn_kernel
.p2align 8
.type attn_kernel,@function
attn_kernel:
    s_cmp_ge_u32 s2, 256
    s_cbranch_scc1 L_attn_end
    s_load_dwordx2 s[8:9], s[0:1], 88
    s_load_dwordx2 s[4:5], s[0:1], 0
    s_load_dwordx2 s[6:7], s[0:1], 64
    s_load_dwordx2 s[42:43], s[0:1], 32
    s_load_dwordx2 s[44:45], s[0:1], 56
    v_and_b32 v1, 63, v0
    v_lshrrev_b32 v4, 6, v0
    v_lshlrev_b32 v2, 4, v1
    v_readfirstlane_b32 s24, v4
    s_and_b32 s28, s2, 7
    s_lshr_b32 s29, s2, 3
    s_and_b32 s30, s29, 3
    s_lshr_b32 s29, s29, 2
    s_lshl_b32 s29, s29, 3
    s_add_u32 s25, s29, s28
    s_lshl_b32 s26, s30, 4
    s_add_u32 s26, s26, s24
    s_sub_u32 s28, s25, 31
    s_cmp_lt_u32 s25, 32
    s_cselect_b32 s31, 0, s28
    s_lshl_b32 s27, s31, 17
    s_add_u32 s27, s27, 4194304
    s_mov_b32 s32, 0x0000ffff
    s_mov_b32 s33, 0x0000ffff
    s_lshl_b32 s28, s25, 16
    s_lshl_b32 s29, s26, 10
    s_add_u32 s40, s28, s29
    s_lshl_b32 s28, s24, 10
    s_add_u32 s29, s28, s27
    s_waitcnt lgkmcnt(0)
    s_mov_b32 s12, s8
    s_and_b32 s13, s9, 0xffff
    s_mov_b32 s14, 20971520
    s_mov_b32 s15, 0x00020000
    s_xor_b32 s30, s28, 1024
    s_add_u32 s34, s30, s27
    s_mov_b32 m0, s28
    s_nop 0
    buffer_load_dwordx4 v2, s[12:15], s29 offen lds
    buffer_load_dwordx4 v[64:67], v2, s[12:15], s40 offen
    s_add_u32 m0, s30, 16384
    s_add_u32 s35, s34, 16384
    buffer_load_dwordx4 v2, s[12:15], s35 offen lds
    s_add_u32 m0, s28, 32768
    s_add_u32 s35, s29, 32768
    buffer_load_dwordx4 v2, s[12:15], s35 offen lds
    s_add_u32 m0, s30, 49152
    s_add_u32 s35, s34, 49152
    buffer_load_dwordx4 v2, s[12:15], s35 offen lds
    s_add_u32 m0, s28, 65536
    s_add_u32 s35, s29, 65536
    buffer_load_dwordx4 v2, s[12:15], s35 offen lds
    s_add_u32 m0, s30, 81920
    s_add_u32 s35, s34, 81920
    buffer_load_dwordx4 v2, s[12:15], s35 offen lds
    s_add_u32 m0, s28, 98304
    s_add_u32 s35, s29, 98304
    buffer_load_dwordx4 v2, s[12:15], s35 offen lds
    s_add_u32 m0, s30, 114688
    s_add_u32 s35, s34, 114688
    buffer_load_dwordx4 v2, s[12:15], s35 offen lds
    s_and_b32 s36, s24, 14
    s_lshl_b32 s36, s36, 10
    v_add_u32 v44, s36, v2
    s_and_b32 s36, s24, 1
    v_and_b32 v4, 27, v1
    v_cmp_eq_u32 vcc, 16, v4
    v_mov_b32 v5, 0x3f803f80
    s_nop 1
    v_cndmask_b32 v28, 0, v5, vcc
    v_cndmask_b32 v29, 0, v5, vcc
    v_cndmask_b32 v30, 0, v5, vcc
    v_cndmask_b32 v31, 0, v5, vcc
    v_cndmask_b32 v32, 0, v5, vcc
    v_cndmask_b32 v33, 0, v5, vcc
    v_cndmask_b32 v34, 0, v5, vcc
    v_cndmask_b32 v35, 0, v5, vcc
    v_mov_b32 v96, 0
    v_mov_b32 v97, 0
    v_mov_b32 v98, 0
    v_mov_b32 v99, 0
    v_mov_b32 v100, 0
    v_mov_b32 v101, 0
    v_mov_b32 v102, 0
    v_mov_b32 v103, 0
    v_mov_b32 v104, 0
    v_mov_b32 v105, 0
    v_mov_b32 v106, 0
    v_mov_b32 v107, 0
    v_mov_b32 v108, 0
    v_mov_b32 v109, 0
    v_mov_b32 v110, 0
    v_mov_b32 v111, 0
    v_mov_b32 v45, 0x3eb8aa3b
    v_mov_b32 v3, v2
    v_mov_b32 v16, 0
    s_waitcnt vmcnt(7)
    s_cmp_lg_u32 s36, 0
    s_cbranch_scc1 L_attn_nc0
    ds_read_b128 v[68:71], v44 offset:0
    s_waitcnt lgkmcnt(0)
    v_lshlrev_b32 v4, 16, v68
    v_and_b32 v5, 0xffff0000, v68
    v_max3_f32 v16, abs(v4), abs(v5), v16
    v_cvt_pkrtz_f16_f32 v68, v4, v5
    v_lshlrev_b32 v4, 16, v69
    v_and_b32 v5, 0xffff0000, v69
    v_max3_f32 v16, abs(v4), abs(v5), v16
    v_cvt_pkrtz_f16_f32 v69, v4, v5
    v_lshlrev_b32 v4, 16, v70
    v_and_b32 v5, 0xffff0000, v70
    v_max3_f32 v16, abs(v4), abs(v5), v16
    v_cvt_pkrtz_f16_f32 v70, v4, v5
    v_lshlrev_b32 v4, 16, v71
    v_and_b32 v5, 0xffff0000, v71
    v_max3_f32 v16, abs(v4), abs(v5), v16
    v_cvt_pkrtz_f16_f32 v71, v4, v5
    ds_write_b128 v44, v[68:71] offset:0
L_attn_nc0:
    v_mov_b32 v8, 0
    v_lshlrev_b32 v4, 16, v64
    v_and_b32 v5, 0xffff0000, v64
    v_mul_f32 v4, v45, v4
    v_mul_f32 v5, v45, v5
    v_max3_f32 v8, abs(v4), abs(v5), v8
    v_cvt_f16_f32 v4, v4
    v_cvt_f16_f32 v5, v5
    v_pack_b32_f16 v12, v4, v5
    v_lshlrev_b32 v4, 16, v65
    v_and_b32 v5, 0xffff0000, v65
    v_mul_f32 v4, v45, v4
    v_mul_f32 v5, v45, v5
    v_max3_f32 v8, abs(v4), abs(v5), v8
    v_cvt_f16_f32 v4, v4
    v_cvt_f16_f32 v5, v5
    v_pack_b32_f16 v13, v4, v5
    v_lshlrev_b32 v4, 16, v66
    v_and_b32 v5, 0xffff0000, v66
    v_mul_f32 v4, v45, v4
    v_mul_f32 v5, v45, v5
    v_max3_f32 v8, abs(v4), abs(v5), v8
    v_cvt_f16_f32 v4, v4
    v_cvt_f16_f32 v5, v5
    v_pack_b32_f16 v14, v4, v5
    v_lshlrev_b32 v4, 16, v67
    v_and_b32 v5, 0xffff0000, v67
    v_mul_f32 v4, v45, v4
    v_mul_f32 v5, v45, v5
    v_max3_f32 v8, abs(v4), abs(v5), v8
    v_cvt_f16_f32 v4, v4
    v_cvt_f16_f32 v5, v5
    v_pack_b32_f16 v15, v4, v5
    v_mov_b32 v4, 0x477fe000
    v_cmp_nle_f32 vcc, v8, v4
    s_mov_b64 s[38:39], vcc
    s_waitcnt lgkmcnt(0)
    s_barrier
    ds_read_b128 v[20:23], v3 offset:0
    ds_read_b128 v[24:27], v3 offset:2048
    s_mov_b64 exec, s[32:33]
    ds_read_b128 v[28:31], v3 offset:1024
    s_mov_b64 exec, -1
    s_waitcnt lgkmcnt(2)
    v_mfma_f32_32x32x16_f16 v[48:63], v[20:23], v[12:15], 0
    s_nop 15
    s_nop 3
    v_max3_f32 v4, v48, v49, v50
    v_max3_f32 v4, v4, v51, v52
    v_max3_f32 v4, v4, v53, v54
    v_max3_f32 v4, v4, v55, v56
    v_max3_f32 v4, v4, v57, v58
    v_max3_f32 v4, v4, v59, v60
    v_max3_f32 v4, v4, v61, v62
    v_max_f32 v4, v4, v63
    v_mov_b32 v5, v4
    s_nop 1
    v_permlane32_swap_b32 v4, v5
    s_nop 1
    v_max_f32 v4, v4, v5
    v_sub_f32 v4, 0xc2200000, v4
    v_add_f32 v64, v48, v4
    v_add_f32 v65, v49, v4
    v_add_f32 v66, v50, v4
    v_add_f32 v67, v51, v4
    v_add_f32 v68, v52, v4
    v_add_f32 v69, v53, v4
    v_add_f32 v70, v54, v4
    v_add_f32 v71, v55, v4
    v_add_f32 v72, v56, v4
    v_add_f32 v73, v57, v4
    v_add_f32 v74, v58, v4
    v_add_f32 v75, v59, v4
    v_add_f32 v76, v60, v4
    v_add_f32 v77, v61, v4
    v_add_f32 v78, v62, v4
    v_add_f32 v79, v63, v4
    v_mov_b32 v48, v4
    v_mov_b32 v49, v4
    v_mov_b32 v50, v4
    v_mov_b32 v51, v4
    v_mov_b32 v52, v4
    v_mov_b32 v53, v4
    v_mov_b32 v54, v4
    v_mov_b32 v55, v4
    v_mov_b32 v56, v4
    v_mov_b32 v57, v4
    v_mov_b32 v58, v4
    v_mov_b32 v59, v4
    v_mov_b32 v60, v4
    v_mov_b32 v61, v4
    v_mov_b32 v62, v4
    v_mov_b32 v63, v4
    v_mov_b32 v40, 0
    v_mov_b32 v41, 0
    v_mov_b32 v42, 0
    v_mov_b32 v43, 0
    s_mov_b32 s34, 0
    s_setprio 3
L_attn_loop:
    s_cmp_eq_u32 s34, 5
    s_cbranch_scc0 L_attn_np40
    s_setprio 2
L_attn_np40:
    s_cmp_eq_u32 s34, 7
    s_cbranch_scc0 L_attn_np56
    s_setprio 1
L_attn_np56:
    s_waitcnt lgkmcnt(1)
    v_mfma_f32_32x32x16_f16 v[80:95], v[24:27], v[12:15], v[48:63]
    ds_read_b128 v[20:23], v3 offset:4096
    v_exp_f32 v64, v64
    v_exp_f32 v65, v65
    v_exp_f32 v66, v66
    v_exp_f32 v67, v67
    v_exp_f32 v68, v68
    v_mfma_f32_32x32x16_bf16 v[96:111], v[32:35], v[40:43], v[96:111]
    s_mov_b64 exec, s[32:33]
    ds_read_b128 v[32:35], v3 offset:1280
    s_mov_b64 exec, -1
    v_exp_f32 v69, v69
    v_exp_f32 v70, v70
    v_exp_f32 v71, v71
    v_cvt_pk_bf16_f32 v36, v64, v65
    v_cvt_pk_bf16_f32 v37, v66, v67
    v_cvt_pk_bf16_f32 v38, v68, v69
    v_cvt_pk_bf16_f32 v39, v70, v71
    v_exp_f32 v72, v72
    v_exp_f32 v73, v73
    s_waitcnt lgkmcnt(2)
    v_mfma_f32_32x32x16_bf16 v[96:111], v[28:31], v[36:39], v[96:111]
    s_mov_b64 exec, s[32:33]
    ds_read_b128 v[28:31], v3 offset:3072
    s_mov_b64 exec, -1
    v_exp_f32 v74, v74
    v_exp_f32 v75, v75
    v_exp_f32 v76, v76
    v_exp_f32 v77, v77
    v_exp_f32 v78, v78
    v_exp_f32 v79, v79
    v_cvt_pk_bf16_f32 v40, v72, v73
    v_cvt_pk_bf16_f32 v41, v74, v75
    v_cvt_pk_bf16_f32 v42, v76, v77
    v_cvt_pk_bf16_f32 v43, v78, v79
    s_waitcnt lgkmcnt(1)
    v_mfma_f32_32x32x16_f16 v[64:79], v[20:23], v[12:15], v[48:63]
    ds_read_b128 v[24:27], v3 offset:6144
    v_exp_f32 v80, v80
    v_exp_f32 v81, v81
    v_exp_f32 v82, v82
    v_exp_f32 v83, v83
    v_exp_f32 v84, v84
    v_mfma_f32_32x32x16_bf16 v[96:111], v[32:35], v[40:43], v[96:111]
    s_mov_b64 exec, s[32:33]
    ds_read_b128 v[32:35], v3 offset:3328
    s_mov_b64 exec, -1
    v_exp_f32 v85, v85
    v_exp_f32 v86, v86
    v_exp_f32 v87, v87
    v_cvt_pk_bf16_f32 v36, v80, v81
    v_cvt_pk_bf16_f32 v37, v82, v83
    v_cvt_pk_bf16_f32 v38, v84, v85
    v_cvt_pk_bf16_f32 v39, v86, v87
    v_exp_f32 v88, v88
    v_exp_f32 v89, v89
    s_waitcnt lgkmcnt(2)
    v_mfma_f32_32x32x16_bf16 v[96:111], v[28:31], v[36:39], v[96:111]
    s_mov_b64 exec, s[32:33]
    ds_read_b128 v[28:31], v3 offset:5120
    s_mov_b64 exec, -1
    v_exp_f32 v90, v90
    v_exp_f32 v91, v91
    v_exp_f32 v92, v92
    v_exp_f32 v93, v93
    v_exp_f32 v94, v94
    v_exp_f32 v95, v95
    v_cvt_pk_bf16_f32 v40, v88, v89
    v_cvt_pk_bf16_f32 v41, v90, v91
    v_cvt_pk_bf16_f32 v42, v92, v93
    v_cvt_pk_bf16_f32 v43, v94, v95
    v_add_u32 v3, 0x1000, v3
    s_waitcnt lgkmcnt(1)
    v_mfma_f32_32x32x16_f16 v[80:95], v[24:27], v[12:15], v[48:63]
    ds_read_b128 v[20:23], v3 offset:4096
    v_exp_f32 v64, v64
    v_exp_f32 v65, v65
    v_exp_f32 v66, v66
    v_exp_f32 v67, v67
    v_exp_f32 v68, v68
    v_mfma_f32_32x32x16_bf16 v[96:111], v[32:35], v[40:43], v[96:111]
    s_mov_b64 exec, s[32:33]
    ds_read_b128 v[32:35], v3 offset:1280
    s_mov_b64 exec, -1
    v_exp_f32 v69, v69
    v_exp_f32 v70, v70
    v_exp_f32 v71, v71
    v_cvt_pk_bf16_f32 v36, v64, v65
    v_cvt_pk_bf16_f32 v37, v66, v67
    v_cvt_pk_bf16_f32 v38, v68, v69
    v_cvt_pk_bf16_f32 v39, v70, v71
    v_exp_f32 v72, v72
    v_exp_f32 v73, v73
    s_waitcnt lgkmcnt(2)
    v_mfma_f32_32x32x16_bf16 v[96:111], v[28:31], v[36:39], v[96:111]
    s_mov_b64 exec, s[32:33]
    ds_read_b128 v[28:31], v3 offset:3072
    s_mov_b64 exec, -1
    v_exp_f32 v74, v74
    v_exp_f32 v75, v75
    v_exp_f32 v76, v76
    v_exp_f32 v77, v77
    v_exp_f32 v78, v78
    v_exp_f32 v79, v79
    v_cvt_pk_bf16_f32 v40, v72, v73
    v_cvt_pk_bf16_f32 v41, v74, v75
    v_cvt_pk_bf16_f32 v42, v76, v77
    v_cvt_pk_bf16_f32 v43, v78, v79
    s_waitcnt lgkmcnt(1)
    v_mfma_f32_32x32x16_f16 v[64:79], v[20:23], v[12:15], v[48:63]
    ds_read_b128 v[24:27], v3 offset:6144
    v_exp_f32 v80, v80
    v_exp_f32 v81, v81
    v_exp_f32 v82, v82
    v_exp_f32 v83, v83
    v_exp_f32 v84, v84
    v_mfma_f32_32x32x16_bf16 v[96:111], v[32:35], v[40:43], v[96:111]
    s_mov_b64 exec, s[32:33]
    ds_read_b128 v[32:35], v3 offset:3328
    s_mov_b64 exec, -1
    v_exp_f32 v85, v85
    v_exp_f32 v86, v86
    v_exp_f32 v87, v87
    v_cvt_pk_bf16_f32 v36, v80, v81
    v_cvt_pk_bf16_f32 v37, v82, v83
    v_cvt_pk_bf16_f32 v38, v84, v85
    v_cvt_pk_bf16_f32 v39, v86, v87
    v_exp_f32 v88, v88
    v_exp_f32 v89, v89
    s_waitcnt lgkmcnt(2)
    v_mfma_f32_32x32x16_bf16 v[96:111], v[28:31], v[36:39], v[96:111]
    s_mov_b64 exec, s[32:33]
    ds_read_b128 v[28:31], v3 offset:5120
    s_mov_b64 exec, -1
    v_exp_f32 v90, v90
    v_exp_f32 v91, v91
    v_exp_f32 v92, v92
    v_exp_f32 v93, v93
    v_exp_f32 v94, v94
    v_exp_f32 v95, v95
    v_cvt_pk_bf16_f32 v40, v88, v89
    v_cvt_pk_bf16_f32 v41, v90, v91
    v_cvt_pk_bf16_f32 v42, v92, v93
    v_cvt_pk_bf16_f32 v43, v94, v95
    v_add_u32 v3, 0x1000, v3
    s_cmp_eq_u32 s34, 7
    s_cbranch_scc0 L_attn_np60
    s_setprio 0
L_attn_np60:
    s_cmp_eq_u32 s34, 0
    s_cbranch_scc0 L_attn_nobar
    s_waitcnt vmcnt(0) lgkmcnt(0)
    s_cmp_lg_u32 s36, 0
    s_cbranch_scc1 L_attn_c_odd
    v_add_u32 v44, 0x8000, v44
    ds_read_b128 v[8:11], v44 offset:0
    s_waitcnt lgkmcnt(0)
    v_lshlrev_b32 v4, 16, v8
    v_and_b32 v5, 0xffff0000, v8
    v_max3_f32 v16, abs(v4), abs(v5), v16
    v_cvt_pkrtz_f16_f32 v8, v4, v5
    v_lshlrev_b32 v4, 16, v9
    v_and_b32 v5, 0xffff0000, v9
    v_max3_f32 v16, abs(v4), abs(v5), v16
    v_cvt_pkrtz_f16_f32 v9, v4, v5
    v_lshlrev_b32 v4, 16, v10
    v_and_b32 v5, 0xffff0000, v10
    v_max3_f32 v16, abs(v4), abs(v5), v16
    v_cvt_pkrtz_f16_f32 v10, v4, v5
    v_lshlrev_b32 v4, 16, v11
    v_and_b32 v5, 0xffff0000, v11
    v_max3_f32 v16, abs(v4), abs(v5), v16
    v_cvt_pkrtz_f16_f32 v11, v4, v5
    ds_write_b128 v44, v[8:11] offset:0
    v_add_u32 v44, 0x8000, v44
    ds_read_b128 v[8:11], v44 offset:0
    s_waitcnt lgkmcnt(0)
    v_lshlrev_b32 v4, 16, v8
    v_and_b32 v5, 0xffff0000, v8
    v_max3_f32 v16, abs(v4), abs(v5), v16
    v_cvt_pkrtz_f16_f32 v8, v4, v5
    v_lshlrev_b32 v4, 16, v9
    v_and_b32 v5, 0xffff0000, v9
    v_max3_f32 v16, abs(v4), abs(v5), v16
    v_cvt_pkrtz_f16_f32 v9, v4, v5
    v_lshlrev_b32 v4, 16, v10
    v_and_b32 v5, 0xffff0000, v10
    v_max3_f32 v16, abs(v4), abs(v5), v16
    v_cvt_pkrtz_f16_f32 v10, v4, v5
    v_lshlrev_b32 v4, 16, v11
    v_and_b32 v5, 0xffff0000, v11
    v_max3_f32 v16, abs(v4), abs(v5), v16
    v_cvt_pkrtz_f16_f32 v11, v4, v5
    ds_write_b128 v44, v[8:11] offset:0
    v_add_u32 v44, 0x8000, v44
    ds_read_b128 v[8:11], v44 offset:0
    s_waitcnt lgkmcnt(0)
    v_lshlrev_b32 v4, 16, v8
    v_and_b32 v5, 0xffff0000, v8
    v_max3_f32 v16, abs(v4), abs(v5), v16
    v_cvt_pkrtz_f16_f32 v8, v4, v5
    v_lshlrev_b32 v4, 16, v9
    v_and_b32 v5, 0xffff0000, v9
    v_max3_f32 v16, abs(v4), abs(v5), v16
    v_cvt_pkrtz_f16_f32 v9, v4, v5
    v_lshlrev_b32 v4, 16, v10
    v_and_b32 v5, 0xffff0000, v10
    v_max3_f32 v16, abs(v4), abs(v5), v16
    v_cvt_pkrtz_f16_f32 v10, v4, v5
    v_lshlrev_b32 v4, 16, v11
    v_and_b32 v5, 0xffff0000, v11
    v_max3_f32 v16, abs(v4), abs(v5), v16
    v_cvt_pkrtz_f16_f32 v11, v4, v5
    ds_write_b128 v44, v[8:11] offset:0
    v_add_u32 v44, 0x8000, v44
    s_branch L_attn_c_done
L_attn_c_odd:
    v_add_u32 v44, 0x4000, v44
    ds_read_b128 v[8:11], v44 offset:0
    s_waitcnt lgkmcnt(0)
    v_lshlrev_b32 v4, 16, v8
    v_and_b32 v5, 0xffff0000, v8
    v_max3_f32 v16, abs(v4), abs(v5), v16
    v_cvt_pkrtz_f16_f32 v8, v4, v5
    v_lshlrev_b32 v4, 16, v9
    v_and_b32 v5, 0xffff0000, v9
    v_max3_f32 v16, abs(v4), abs(v5), v16
    v_cvt_pkrtz_f16_f32 v9, v4, v5
    v_lshlrev_b32 v4, 16, v10
    v_and_b32 v5, 0xffff0000, v10
    v_max3_f32 v16, abs(v4), abs(v5), v16
    v_cvt_pkrtz_f16_f32 v10, v4, v5
    v_lshlrev_b32 v4, 16, v11
    v_and_b32 v5, 0xffff0000, v11
    v_max3_f32 v16, abs(v4), abs(v5), v16
    v_cvt_pkrtz_f16_f32 v11, v4, v5
    ds_write_b128 v44, v[8:11] offset:0
    v_add_u32 v44, 0x8000, v44
    ds_read_b128 v[8:11], v44 offset:0
    s_waitcnt lgkmcnt(0)
    v_lshlrev_b32 v4, 16, v8
    v_and_b32 v5, 0xffff0000, v8
    v_max3_f32 v16, abs(v4), abs(v5), v16
    v_cvt_pkrtz_f16_f32 v8, v4, v5
    v_lshlrev_b32 v4, 16, v9
    v_and_b32 v5, 0xffff0000, v9
    v_max3_f32 v16, abs(v4), abs(v5), v16
    v_cvt_pkrtz_f16_f32 v9, v4, v5
    v_lshlrev_b32 v4, 16, v10
    v_and_b32 v5, 0xffff0000, v10
    v_max3_f32 v16, abs(v4), abs(v5), v16
    v_cvt_pkrtz_f16_f32 v10, v4, v5
    v_lshlrev_b32 v4, 16, v11
    v_and_b32 v5, 0xffff0000, v11
    v_max3_f32 v16, abs(v4), abs(v5), v16
    v_cvt_pkrtz_f16_f32 v11, v4, v5
    ds_write_b128 v44, v[8:11] offset:0
    v_add_u32 v44, 0x8000, v44
    ds_read_b128 v[8:11], v44 offset:0
    s_waitcnt lgkmcnt(0)
    v_lshlrev_b32 v4, 16, v8
    v_and_b32 v5, 0xffff0000, v8
    v_max3_f32 v16, abs(v4), abs(v5), v16
    v_cvt_pkrtz_f16_f32 v8, v4, v5
    v_lshlrev_b32 v4, 16, v9
    v_and_b32 v5, 0xffff0000, v9
    v_max3_f32 v16, abs(v4), abs(v5), v16
    v_cvt_pkrtz_f16_f32 v9, v4, v5
    v_lshlrev_b32 v4, 16, v10
    v_and_b32 v5, 0xffff0000, v10
    v_max3_f32 v16, abs(v4), abs(v5), v16
    v_cvt_pkrtz_f16_f32 v10, v4, v5
    v_lshlrev_b32 v4, 16, v11
    v_and_b32 v5, 0xffff0000, v11
    v_max3_f32 v16, abs(v4), abs(v5), v16
    v_cvt_pkrtz_f16_f32 v11, v4, v5
    ds_write_b128 v44, v[8:11] offset:0
    v_add_u32 v44, 0x8000, v44
    ds_read_b128 v[8:11], v44 offset:0
    s_waitcnt lgkmcnt(0)
    v_lshlrev_b32 v4, 16, v8
    v_and_b32 v5, 0xffff0000, v8
    v_max3_f32 v16, abs(v4), abs(v5), v16
    v_cvt_pkrtz_f16_f32 v8, v4, v5
    v_lshlrev_b32 v4, 16, v9
    v_and_b32 v5, 0xffff0000, v9
    v_max3_f32 v16, abs(v4), abs(v5), v16
    v_cvt_pkrtz_f16_f32 v9, v4, v5
    v_lshlrev_b32 v4, 16, v10
    v_and_b32 v5, 0xffff0000, v10
    v_max3_f32 v16, abs(v4), abs(v5), v16
    v_cvt_pkrtz_f16_f32 v10, v4, v5
    v_lshlrev_b32 v4, 16, v11
    v_and_b32 v5, 0xffff0000, v11
    v_max3_f32 v16, abs(v4), abs(v5), v16
    v_cvt_pkrtz_f16_f32 v11, v4, v5
    ds_write_b128 v44, v[8:11] offset:0
    v_add_u32 v44, 0x8000, v44
L_attn_c_done:
    v_mov_b32 v4, 0x477fe000
    v_cmp_nle_f32 vcc, v16, v4
    s_cmp_lg_u64 vcc, 0
    s_cselect_b32 s28, 1, 0
    s_lshl_b32 s29, s24, 2
    s_add_u32 s29, s29, 139264
    v_mov_b32 v4, s28
    v_mov_b32 v5, s29
    ds_write_b32 v5, v4
    s_waitcnt lgkmcnt(0)
    s_barrier
    s_lshr_b32 s28, s2, 3
    s_lshl_b32 s28, s28, 4
    s_add_u32 s28, s28, s24
    s_cmp_lt_u32 s28, 256
    s_cselect_b32 s48, s42, s44
    s_cselect_b32 s29, s43, s45
    s_and_b32 s49, s29, 0xffff
    s_mov_b32 s50, 524288
    s_mov_b32 s51, 0x00020000
    s_and_b32 s28, s28, 255
    s_lshl_b32 s28, s28, 11
    buffer_load_dwordx4 v[16:19], v2, s[48:51], s28 offen
    buffer_load_dwordx4 v[16:19], v2, s[48:51], s28 offen offset:1024
L_attn_nobar:
    s_waitcnt lgkmcnt(1)
    v_mfma_f32_32x32x16_f16 v[80:95], v[24:27], v[12:15], v[48:63]
    ds_read_b128 v[20:23], v3 offset:4096
    v_exp_f32 v64, v64
    v_exp_f32 v65, v65
    v_exp_f32 v66, v66
    v_exp_f32 v67, v67
    v_exp_f32 v68, v68
    v_mfma_f32_32x32x16_bf16 v[96:111], v[32:35], v[40:43], v[96:111]
    s_mov_b64 exec, s[32:33]
    ds_read_b128 v[32:35], v3 offset:1280
    s_mov_b64 exec, -1
    v_exp_f32 v69, v69
    v_exp_f32 v70, v70
    v_exp_f32 v71, v71
    v_cvt_pk_bf16_f32 v36, v64, v65
    v_cvt_pk_bf16_f32 v37, v66, v67
    v_cvt_pk_bf16_f32 v38, v68, v69
    v_cvt_pk_bf16_f32 v39, v70, v71
    v_exp_f32 v72, v72
    v_exp_f32 v73, v73
    s_waitcnt lgkmcnt(2)
    v_mfma_f32_32x32x16_bf16 v[96:111], v[28:31], v[36:39], v[96:111]
    s_mov_b64 exec, s[32:33]
    ds_read_b128 v[28:31], v3 offset:3072
    s_mov_b64 exec, -1
    v_exp_f32 v74, v74
    v_exp_f32 v75, v75
    v_exp_f32 v76, v76
    v_exp_f32 v77, v77
    v_exp_f32 v78, v78
    v_exp_f32 v79, v79
    v_cvt_pk_bf16_f32 v40, v72, v73
    v_cvt_pk_bf16_f32 v41, v74, v75
    v_cvt_pk_bf16_f32 v42, v76, v77
    v_cvt_pk_bf16_f32 v43, v78, v79
    s_waitcnt lgkmcnt(1)
    v_mfma_f32_32x32x16_f16 v[64:79], v[20:23], v[12:15], v[48:63]
    ds_read_b128 v[24:27], v3 offset:6144
    v_exp_f32 v80, v80
    v_exp_f32 v81, v81
    v_exp_f32 v82, v82
    v_exp_f32 v83, v83
    v_exp_f32 v84, v84
    v_mfma_f32_32x32x16_bf16 v[96:111], v[32:35], v[40:43], v[96:111]
    s_mov_b64 exec, s[32:33]
    ds_read_b128 v[32:35], v3 offset:3328
    s_mov_b64 exec, -1
    v_exp_f32 v85, v85
    v_exp_f32 v86, v86
    v_exp_f32 v87, v87
    v_cvt_pk_bf16_f32 v36, v80, v81
    v_cvt_pk_bf16_f32 v37, v82, v83
    v_cvt_pk_bf16_f32 v38, v84, v85
    v_cvt_pk_bf16_f32 v39, v86, v87
    v_exp_f32 v88, v88
    v_exp_f32 v89, v89
    s_waitcnt lgkmcnt(2)
    v_mfma_f32_32x32x16_bf16 v[96:111], v[28:31], v[36:39], v[96:111]
    s_mov_b64 exec, s[32:33]
    ds_read_b128 v[28:31], v3 offset:5120
    s_mov_b64 exec, -1
    v_exp_f32 v90, v90
    v_exp_f32 v91, v91
    v_exp_f32 v92, v92
    v_exp_f32 v93, v93
    v_exp_f32 v94, v94
    v_exp_f32 v95, v95
    v_cvt_pk_bf16_f32 v40, v88, v89
    v_cvt_pk_bf16_f32 v41, v90, v91
    v_cvt_pk_bf16_f32 v42, v92, v93
    v_cvt_pk_bf16_f32 v43, v94, v95
    v_add_u32 v3, 0x1000, v3
    s_waitcnt lgkmcnt(1)
    v_mfma_f32_32x32x16_f16 v[80:95], v[24:27], v[12:15], v[48:63]
    ds_read_b128 v[20:23], v3 offset:4096
    v_exp_f32 v64, v64
    v_exp_f32 v65, v65
    v_exp_f32 v66, v66
    v_exp_f32 v67, v67
    v_exp_f32 v68, v68
    v_mfma_f32_32x32x16_bf16 v[96:111], v[32:35], v[40:43], v[96:111]
    s_mov_b64 exec, s[32:33]
    ds_read_b128 v[32:35], v3 offset:1280
    s_mov_b64 exec, -1
    v_exp_f32 v69, v69
    v_exp_f32 v70, v70
    v_exp_f32 v71, v71
    v_cvt_pk_bf16_f32 v36, v64, v65
    v_cvt_pk_bf16_f32 v37, v66, v67
    v_cvt_pk_bf16_f32 v38, v68, v69
    v_cvt_pk_bf16_f32 v39, v70, v71
    v_exp_f32 v72, v72
    v_exp_f32 v73, v73
    s_waitcnt lgkmcnt(2)
    v_mfma_f32_32x32x16_bf16 v[96:111], v[28:31], v[36:39], v[96:111]
    s_mov_b64 exec, s[32:33]
    ds_read_b128 v[28:31], v3 offset:3072
    s_mov_b64 exec, -1
    v_exp_f32 v74, v74
    v_exp_f32 v75, v75
    v_exp_f32 v76, v76
    v_exp_f32 v77, v77
    v_exp_f32 v78, v78
    v_exp_f32 v79, v79
    v_cvt_pk_bf16_f32 v40, v72, v73
    v_cvt_pk_bf16_f32 v41, v74, v75
    v_cvt_pk_bf16_f32 v42, v76, v77
    v_cvt_pk_bf16_f32 v43, v78, v79
    s_waitcnt lgkmcnt(1)
    v_mfma_f32_32x32x16_f16 v[64:79], v[20:23], v[12:15], v[48:63]
    ds_read_b128 v[24:27], v3 offset:6144
    v_exp_f32 v80, v80
    v_exp_f32 v81, v81
    v_exp_f32 v82, v82
    v_exp_f32 v83, v83
    v_exp_f32 v84, v84
    v_mfma_f32_32x32x16_bf16 v[96:111], v[32:35], v[40:43], v[96:111]
    s_mov_b64 exec, s[32:33]
    ds_read_b128 v[32:35], v3 offset:3328
    s_mov_b64 exec, -1
    v_exp_f32 v85, v85
    v_exp_f32 v86, v86
    v_exp_f32 v87, v87
    v_cvt_pk_bf16_f32 v36, v80, v81
    v_cvt_pk_bf16_f32 v37, v82, v83
    v_cvt_pk_bf16_f32 v38, v84, v85
    v_cvt_pk_bf16_f32 v39, v86, v87
    v_exp_f32 v88, v88
    v_exp_f32 v89, v89
    s_waitcnt lgkmcnt(2)
    v_mfma_f32_32x32x16_bf16 v[96:111], v[28:31], v[36:39], v[96:111]
    s_mov_b64 exec, s[32:33]
    ds_read_b128 v[28:31], v3 offset:5120
    s_mov_b64 exec, -1
    v_exp_f32 v90, v90
    v_exp_f32 v91, v91
    v_exp_f32 v92, v92
    v_exp_f32 v93, v93
    v_exp_f32 v94, v94
    v_exp_f32 v95, v95
    v_cvt_pk_bf16_f32 v40, v88, v89
    v_cvt_pk_bf16_f32 v41, v90, v91
    v_cvt_pk_bf16_f32 v42, v92, v93
    v_cvt_pk_bf16_f32 v43, v94, v95
    v_add_u32 v3, 0x1000, v3
    s_add_u32 s34, s34, 1
    s_cmp_lt_u32 s34, 8
    s_cbranch_scc1 L_attn_loop
    s_waitcnt lgkmcnt(0)
    v_mfma_f32_32x32x16_bf16 v[96:111], v[32:35], v[40:43], v[96:111]
    s_nop 15
    s_nop 3
    v_and_b32 v4, 15, v1
    v_lshlrev_b32 v4, 2, v4
    v_add_u32 v4, 139264, v4
    ds_read_b32 v5, v4
    s_waitcnt lgkmcnt(0)
    v_cmp_ne_u32 vcc, 0, v5
    s_or_b64 s[38:39], s[38:39], vcc
    v_mov_b32 v4, 0x7b800000
    v_cmp_nlt_f32 vcc, v104, v4
    s_or_b64 s[38:39], s[38:39], vcc
    v_cmp_nlt_f32 vcc, abs(v96), v4
    s_or_b64 s[38:39], s[38:39], vcc
    v_cmp_nlt_f32 vcc, abs(v97), v4
    s_or_b64 s[38:39], s[38:39], vcc
    v_cmp_nlt_f32 vcc, abs(v98), v4
    s_or_b64 s[38:39], s[38:39], vcc
    v_cmp_nlt_f32 vcc, abs(v99), v4
    s_or_b64 s[38:39], s[38:39], vcc
    v_cmp_nlt_f32 vcc, abs(v100), v4
    s_or_b64 s[38:39], s[38:39], vcc
    v_cmp_nlt_f32 vcc, abs(v101), v4
    s_or_b64 s[38:39], s[38:39], vcc
    v_cmp_nlt_f32 vcc, abs(v102), v4
    s_or_b64 s[38:39], s[38:39], vcc
    v_cmp_nlt_f32 vcc, abs(v103), v4
    s_or_b64 s[38:39], s[38:39], vcc
    s_cmp_eq_u64 s[38:39], 0
    s_cbranch_scc0 L_attn_slow
L_attn_epi:
    v_rcp_f32 v4, v104
    s_nop 0
    v_mul_f32 v96, v96, v4
    v_mul_f32 v97, v97, v4
    v_mul_f32 v98, v98, v4
    v_mul_f32 v99, v99, v4
    v_mul_f32 v100, v100, v4
    v_mul_f32 v101, v101, v4
    v_mul_f32 v102, v102, v4
    v_mul_f32 v103, v103, v4
    v_cvt_pk_bf16_f32 v36, v96, v97
    v_cvt_pk_bf16_f32 v37, v98, v99
    v_cvt_pk_bf16_f32 v38, v100, v101
    v_cvt_pk_bf16_f32 v39, v102, v103
    s_add_u32 s28, s40, 9437184
    buffer_store_dwordx4 v[36:39], v2, s[12:15], s28 offen sc0 sc1
L_attn_end:
    s_endpgm
L_attn_slow:
    s_setprio 0
    buffer_load_dwordx4 v[64:67], v2, s[12:15], s40 offen
    v_mov_b32 v3, v2
    v_mov_b32 v96, 0
    v_mov_b32 v97, 0
    v_mov_b32 v98, 0
    v_mov_b32 v99, 0
    v_mov_b32 v100, 0
    v_mov_b32 v101, 0
    v_mov_b32 v102, 0
    v_mov_b32 v103, 0
    v_mov_b32 v104, 0
    v_mov_b32 v105, 0
    v_mov_b32 v106, 0
    v_mov_b32 v107, 0
    v_mov_b32 v108, 0
    v_mov_b32 v109, 0
    v_mov_b32 v110, 0
    v_mov_b32 v111, 0
    v_mov_b32 v44, 0xff7fffff
    s_mov_b32 s34, 0
    s_mov_b32 s30, s27
    s_waitcnt vmcnt(0)
    v_lshlrev_b32 v4, 16, v64
    v_and_b32 v5, 0xffff0000, v64
    v_mul_f32 v4, v45, v4
    v_mul_f32 v5, v45, v5
    v_cvt_pk_bf16_f32 v12, v4, v5
    v_lshlrev_b32 v6, 16, v12
    v_and_b32 v7, 0xffff0000, v12
    v_sub_f32 v4, v4, v6
    v_sub_f32 v5, v5, v7
    v_cvt_pk_bf16_f32 v16, v4, v5
    v_lshlrev_b32 v4, 16, v65
    v_and_b32 v5, 0xffff0000, v65
    v_mul_f32 v4, v45, v4
    v_mul_f32 v5, v45, v5
    v_cvt_pk_bf16_f32 v13, v4, v5
    v_lshlrev_b32 v6, 16, v13
    v_and_b32 v7, 0xffff0000, v13
    v_sub_f32 v4, v4, v6
    v_sub_f32 v5, v5, v7
    v_cvt_pk_bf16_f32 v17, v4, v5
    v_lshlrev_b32 v4, 16, v66
    v_and_b32 v5, 0xffff0000, v66
    v_mul_f32 v4, v45, v4
    v_mul_f32 v5, v45, v5
    v_cvt_pk_bf16_f32 v14, v4, v5
    v_lshlrev_b32 v6, 16, v14
    v_and_b32 v7, 0xffff0000, v14
    v_sub_f32 v4, v4, v6
    v_sub_f32 v5, v5, v7
    v_cvt_pk_bf16_f32 v18, v4, v5
    v_lshlrev_b32 v4, 16, v67
    v_and_b32 v5, 0xffff0000, v67
    v_mul_f32 v4, v45, v4
    v_mul_f32 v5, v45, v5
    v_cvt_pk_bf16_f32 v15, v4, v5
    v_lshlrev_b32 v6, 16, v15
    v_and_b32 v7, 0xffff0000, v15
    v_sub_f32 v4, v4, v6
    v_sub_f32 v5, v5, v7
    v_cvt_pk_bf16_f32 v19, v4, v5
L_attn_slow_loop:
    buffer_load_dwordx4 v[20:23], v2, s[12:15], s30 offen
    s_mov_b64 exec, s[32:33]
    ds_read_b128 v[28:31], v3 offset:1024
    s_mov_b64 exec, -1
    s_mov_b64 exec, s[32:33]
    ds_read_b128 v[32:35], v3 offset:1280
    s_mov_b64 exec, -1
    s_waitcnt vmcnt(0) lgkmcnt(0)
    v_mfma_f32_32x32x16_bf16 v[64:79], v[20:23], v[12:15], 0
    v_mfma_f32_32x32x16_bf16 v[64:79], v[20:23], v[16:19], v[64:79]
    s_nop 15
    s_nop 3
    v_max3_f32 v4, v64, v65, v66
    v_max3_f32 v4, v4, v67, v68
    v_max3_f32 v4, v4, v69, v70
    v_max3_f32 v4, v4, v71, v72
    v_max3_f32 v4, v4, v73, v74
    v_max3_f32 v4, v4, v75, v76
    v_max3_f32 v4, v4, v77, v78
    v_max_f32 v4, v4, v79
    v_mov_b32 v5, v4
    s_nop 1
    v_permlane32_swap_b32 v4, v5
    s_nop 1
    v_max_f32 v4, v4, v5
    v_max_f32 v4, v4, v44
    v_sub_f32 v5, v44, v4
    v_exp_f32 v5, v5
    v_mov_b32 v44, v4
    v_mul_f32 v96, v96, v5
    v_mul_f32 v97, v97, v5
    v_mul_f32 v98, v98, v5
    v_mul_f32 v99, v99, v5
    v_mul_f32 v100, v100, v5
    v_mul_f32 v101, v101, v5
    v_mul_f32 v102, v102, v5
    v_mul_f32 v103, v103, v5
    v_mul_f32 v104, v104, v5
    v_mul_f32 v105, v105, v5
    v_mul_f32 v106, v106, v5
    v_mul_f32 v107, v107, v5
    v_mul_f32 v108, v108, v5
    v_mul_f32 v109, v109, v5
    v_mul_f32 v110, v110, v5
    v_mul_f32 v111, v111, v5
    v_sub_f32 v64, v64, v44
    v_exp_f32 v64, v64
    v_sub_f32 v65, v65, v44
    v_exp_f32 v65, v65
    v_sub_f32 v66, v66, v44
    v_exp_f32 v66, v66
    v_sub_f32 v67, v67, v44
    v_exp_f32 v67, v67
    v_sub_f32 v68, v68, v44
    v_exp_f32 v68, v68
    v_sub_f32 v69, v69, v44
    v_exp_f32 v69, v69
    v_sub_f32 v70, v70, v44
    v_exp_f32 v70, v70
    v_sub_f32 v71, v71, v44
    v_exp_f32 v71, v71
    v_sub_f32 v72, v72, v44
    v_exp_f32 v72, v72
    v_sub_f32 v73, v73, v44
    v_exp_f32 v73, v73
    v_sub_f32 v74, v74, v44
    v_exp_f32 v74, v74
    v_sub_f32 v75, v75, v44
    v_exp_f32 v75, v75
    v_sub_f32 v76, v76, v44
    v_exp_f32 v76, v76
    v_sub_f32 v77, v77, v44
    v_exp_f32 v77, v77
    v_sub_f32 v78, v78, v44
    v_exp_f32 v78, v78
    v_sub_f32 v79, v79, v44
    v_exp_f32 v79, v79
    s_nop 0
    v_cvt_pk_bf16_f32 v36, v64, v65
    v_cvt_pk_bf16_f32 v37, v66, v67
    v_cvt_pk_bf16_f32 v38, v68, v69
    v_cvt_pk_bf16_f32 v39, v70, v71
    v_cvt_pk_bf16_f32 v40, v72, v73
    v_cvt_pk_bf16_f32 v41, v74, v75
    v_cvt_pk_bf16_f32 v42, v76, v77
    v_cvt_pk_bf16_f32 v43, v78, v79
    s_nop 1
    v_mfma_f32_32x32x16_bf16 v[96:111], v[28:31], v[36:39], v[96:111]
    v_mfma_f32_32x32x16_bf16 v[96:111], v[32:35], v[40:43], v[96:111]
    s_nop 15
    s_nop 3
    v_add_u32 v3, 0x800, v3
    s_add_u32 s30, s30, 2048
    s_add_u32 s34, s34, 1
    s_cmp_lt_u32 s34, 64
    s_cbranch_scc1 L_attn_slow_loop
    s_branch L_attn_epi
.text
.globl out_kernel
.p2align 8
.type out_kernel,@function
out_kernel:
    s_cmp_ge_u32 s2, 256
    s_cbranch_scc1 L_out_end
    s_load_dwordx2 s[10:11], s[0:1], 88
    s_load_dwordx2 s[4:5], s[0:1], 32
    s_load_dwordx2 s[6:7], s[0:1], 56
    s_load_dwordx2 s[8:9], s[0:1], 72
    v_and_b32 v1, 63, v0
    v_lshrrev_b32 v5, 6, v0
    v_lshlrev_b32 v2, 4, v1
    v_readfirstlane_b32 s30, v5
    s_and_b32 s34, s2, 7
    s_lshl_b32 s34, s34, 2
    s_lshr_b32 s35, s2, 3
    s_and_b32 s35, s35, 3
    s_add_u32 s28, s34, s35
    s_lshr_b32 s29, s2, 5
    s_and_b32 s31, s30, 1
    s_lshr_b32 s40, s30, 1
    s_and_b32 s32, s40, 1
    s_lshr_b32 s33, s30, 2
    v_lshrrev_b32 v5, 3, v1
    v_lshlrev_b32 v6, 10, v5
    v_lshrrev_b32 v5, 1, v5
    v_and_b32 v5, 1, v5
    v_lshlrev_b32 v5, 2, v5
    v_and_b32 v7, 7, v1
    v_xor_b32 v5, v5, v7
    v_lshlrev_b32 v5, 4, v5
    v_add_u32 v3, v5, v6
    s_lshl_b32 s34, s28, 1
    s_add_u32 s34, s34, s31
    s_lshl_b32 s37, s34, 10
    s_lshl_b32 s35, s40, 20
    s_add_u32 s37, s37, s35
    s_add_u32 s37, s37, 9437184
    s_lshl_b32 s38, s29, 7
    s_lshl_b32 s34, s32, 18
    s_add_u32 s38, s38, s34
    s_lshl_b32 s34, s31, 15
    s_add_u32 s38, s38, s34
    s_lshl_b32 s39, s40, 15
    s_lshl_b32 s34, s31, 12
    s_add_u32 s39, s39, s34
    s_waitcnt lgkmcnt(0)
    s_mov_b32 s24, s10
    s_and_b32 s25, s11, 0xffff
    s_mov_b32 s26, 20971520
    s_mov_b32 s27, 0x00020000
    s_cmp_eq_u32 s33, 0
    s_cselect_b32 s12, s4, s6
    s_cselect_b32 s34, s5, s7
    s_and_b32 s13, s34, 0xffff
    s_mov_b32 s14, 524288
    s_mov_b32 s15, 0x00020000
    s_add_u32 s34, s37, 0
    buffer_load_dwordx4 v[64:67], v2, s[24:27], s34 offen
    s_add_u32 s34, s37, 65536
    buffer_load_dwordx4 v[68:71], v2, s[24:27], s34 offen
    s_add_u32 s34, s37, 131072
    buffer_load_dwordx4 v[72:75], v2, s[24:27], s34 offen
    s_add_u32 s34, s37, 196608
    buffer_load_dwordx4 v[76:79], v2, s[24:27], s34 offen
    s_add_u32 m0, s39, 0
    s_add_u32 s34, s38, 0
    buffer_load_dwordx4 v3, s[12:15], s34 offen lds
    s_add_u32 m0, s39, 1024
    s_add_u32 s34, s38, 8192
    buffer_load_dwordx4 v3, s[12:15], s34 offen lds
    s_add_u32 m0, s39, 2048
    s_add_u32 s34, s38, 16384
    buffer_load_dwordx4 v3, s[12:15], s34 offen lds
    s_add_u32 m0, s39, 3072
    s_add_u32 s34, s38, 24576
    buffer_load_dwordx4 v3, s[12:15], s34 offen lds
    s_add_u32 s34, s37, 262144
    buffer_load_dwordx4 v[80:83], v2, s[24:27], s34 offen
    s_add_u32 s34, s37, 327680
    buffer_load_dwordx4 v[84:87], v2, s[24:27], s34 offen
    s_add_u32 s34, s37, 393216
    buffer_load_dwordx4 v[88:91], v2, s[24:27], s34 offen
    s_add_u32 s34, s37, 458752
    buffer_load_dwordx4 v[92:95], v2, s[24:27], s34 offen
    s_add_u32 m0, s39, 8192
    s_add_u32 s34, s38, 65536
    buffer_load_dwordx4 v3, s[12:15], s34 offen lds
    s_add_u32 m0, s39, 9216
    s_add_u32 s34, s38, 73728
    buffer_load_dwordx4 v3, s[12:15], s34 offen lds
    s_add_u32 m0, s39, 10240
    s_add_u32 s34, s38, 81920
    buffer_load_dwordx4 v3, s[12:15], s34 offen lds
    s_add_u32 m0, s39, 11264
    s_add_u32 s34, s38, 90112
    buffer_load_dwordx4 v3, s[12:15], s34 offen lds
    s_add_u32 s34, s37, 524288
    buffer_load_dwordx4 v[96:99], v2, s[24:27], s34 offen
    s_add_u32 s34, s37, 589824
    buffer_load_dwordx4 v[100:103], v2, s[24:27], s34 offen
    s_add_u32 s34, s37, 655360
    buffer_load_dwordx4 v[104:107], v2, s[24:27], s34 offen
    s_add_u32 s34, s37, 720896
    buffer_load_dwordx4 v[108:111], v2, s[24:27], s34 offen
    s_add_u32 m0, s39, 16384
    s_add_u32 s34, s38, 131072
    buffer_load_dwordx4 v3, s[12:15], s34 offen lds
    s_add_u32 m0, s39, 17408
    s_add_u32 s34, s38, 139264
    buffer_load_dwordx4 v3, s[12:15], s34 offen lds
    s_add_u32 m0, s39, 18432
    s_add_u32 s34, s38, 147456
    buffer_load_dwordx4 v3, s[12:15], s34 offen lds
    s_add_u32 m0, s39, 19456
    s_add_u32 s34, s38, 155648
    buffer_load_dwordx4 v3, s[12:15], s34 offen lds
    s_add_u32 s34, s37, 786432
    buffer_load_dwordx4 v[112:115], v2, s[24:27], s34 offen
    s_add_u32 s34, s37, 851968
    buffer_load_dwordx4 v[116:119], v2, s[24:27], s34 offen
    s_add_u32 s34, s37, 917504
    buffer_load_dwordx4 v[120:123], v2, s[24:27], s34 offen
    s_add_u32 s34, s37, 983040
    buffer_load_dwordx4 v[124:127], v2, s[24:27], s34 offen
    s_add_u32 m0, s39, 24576
    s_add_u32 s34, s38, 196608
    buffer_load_dwordx4 v3, s[12:15], s34 offen lds
    s_add_u32 m0, s39, 25600
    s_add_u32 s34, s38, 204800
    buffer_load_dwordx4 v3, s[12:15], s34 offen lds
    s_add_u32 m0, s39, 26624
    s_add_u32 s34, s38, 212992
    buffer_load_dwordx4 v3, s[12:15], s34 offen lds
    s_add_u32 m0, s39, 27648
    s_add_u32 s34, s38, 221184
    buffer_load_dwordx4 v3, s[12:15], s34 offen lds
    v_lshrrev_b32 v5, 3, v1
    s_lshl_b32 s34, s40, 3
    v_add_u32 v5, s34, v5
    v_lshlrev_b32 v5, 2, v5
    s_lshl_b32 s34, s28, 1
    s_add_u32 s34, s34, s31
    s_lshl_b32 s34, s34, 7
    s_add_u32 s34, s34, 13631488
    buffer_load_dword v12, v5, s[24:27], s34 offen
    s_add_u32 s34, s34, 8192
    buffer_load_dword v13, v5, s[24:27], s34 offen
    s_mov_b32 s20, s8
    s_and_b32 s21, s9, 0xffff
    s_mov_b32 s22, 2097152
    s_mov_b32 s23, 0x00020000
    v_lshrrev_b32 v5, 5, v1
    v_lshrrev_b32 v6, 2, v1
    v_and_b32 v6, 3, v6
    v_lshl_add_u32 v5, v5, 2, v6
    v_lshlrev_b32 v5, 7, v5
    v_lshrrev_b32 v6, 1, v6
    v_lshlrev_b32 v6, 6, v6
    v_add_u32 v5, v5, v6
    v_lshrrev_b32 v6, 4, v1
    v_and_b32 v6, 1, v6
    v_lshlrev_b32 v6, 5, v6
    v_add_u32 v5, v5, v6
    v_and_b32 v6, 3, v1
    v_lshlrev_b32 v6, 3, v6
    v_add_u32 v5, v5, v6
    s_lshl_b32 s34, s40, 15
    v_add_u32 v4, s34, v5
    v_xor_b32 v15, 64, v4
    s_lshl_b32 s34, s30, 13
    v_add_u32 v14, s34, v2
    v_mov_b32 v32, 0
    v_mov_b32 v33, 0
    v_mov_b32 v34, 0
    v_mov_b32 v35, 0
    v_mov_b32 v36, 0
    v_mov_b32 v37, 0
    v_mov_b32 v38, 0
    v_mov_b32 v39, 0
    v_mov_b32 v40, 0
    v_mov_b32 v41, 0
    v_mov_b32 v42, 0
    v_mov_b32 v43, 0
    v_mov_b32 v44, 0
    v_mov_b32 v45, 0
    v_mov_b32 v46, 0
    v_mov_b32 v47, 0
    v_mov_b32 v48, 0
    v_mov_b32 v49, 0
    v_mov_b32 v50, 0
    v_mov_b32 v51, 0
    v_mov_b32 v52, 0
    v_mov_b32 v53, 0
    v_mov_b32 v54, 0
    v_mov_b32 v55, 0
    v_mov_b32 v56, 0
    v_mov_b32 v57, 0
    v_mov_b32 v58, 0
    v_mov_b32 v59, 0
    v_mov_b32 v60, 0
    v_mov_b32 v61, 0
    v_mov_b32 v62, 0
    v_mov_b32 v63, 0
    s_waitcnt vmcnt(26)
    s_barrier
    ds_read_b64_tr_b16 v[16:17], v4 offset:0
    ds_read_b64_tr_b16 v[18:19], v4 offset:1024
    ds_read_b64_tr_b16 v[20:21], v15 offset:0
    ds_read_b64_tr_b16 v[22:23], v15 offset:1024
    ds_read_b64_tr_b16 v[24:25], v4 offset:2048
    ds_read_b64_tr_b16 v[26:27], v4 offset:3072
    ds_read_b64_tr_b16 v[28:29], v15 offset:2048
    ds_read_b64_tr_b16 v[30:31], v15 offset:3072
    s_waitcnt lgkmcnt(4)
    v_mfma_f32_32x32x16_bf16 v[32:47], v[16:19], v[64:67], v[32:47]
    v_mfma_f32_32x32x16_bf16 v[48:63], v[20:23], v[64:67], v[48:63]
    ds_read_b64_tr_b16 v[16:17], v4 offset:4096
    ds_read_b64_tr_b16 v[18:19], v4 offset:5120
    ds_read_b64_tr_b16 v[20:21], v15 offset:4096
    ds_read_b64_tr_b16 v[22:23], v15 offset:5120
    s_waitcnt lgkmcnt(4)
    v_mfma_f32_32x32x16_bf16 v[32:47], v[24:27], v[68:71], v[32:47]
    v_mfma_f32_32x32x16_bf16 v[48:63], v[28:31], v[68:71], v[48:63]
    ds_read_b64_tr_b16 v[24:25], v4 offset:6144
    ds_read_b64_tr_b16 v[26:27], v4 offset:7168
    ds_read_b64_tr_b16 v[28:29], v15 offset:6144
    ds_read_b64_tr_b16 v[30:31], v15 offset:7168
    s_waitcnt lgkmcnt(4)
    v_mfma_f32_32x32x16_bf16 v[32:47], v[16:19], v[72:75], v[32:47]
    v_mfma_f32_32x32x16_bf16 v[48:63], v[20:23], v[72:75], v[48:63]
    s_waitcnt lgkmcnt(0)
    v_mfma_f32_32x32x16_bf16 v[32:47], v[24:27], v[76:79], v[32:47]
    v_mfma_f32_32x32x16_bf16 v[48:63], v[28:31], v[76:79], v[48:63]
    s_waitcnt vmcnt(18)
    s_barrier
    ds_read_b64_tr_b16 v[16:17], v4 offset:8192
    ds_read_b64_tr_b16 v[18:19], v4 offset:9216
    ds_read_b64_tr_b16 v[20:21], v15 offset:8192
    ds_read_b64_tr_b16 v[22:23], v15 offset:9216
    ds_read_b64_tr_b16 v[24:25], v4 offset:10240
    ds_read_b64_tr_b16 v[26:27], v4 offset:11264
    ds_read_b64_tr_b16 v[28:29], v15 offset:10240
    ds_read_b64_tr_b16 v[30:31], v15 offset:11264
    s_waitcnt lgkmcnt(4)
    v_mfma_f32_32x32x16_bf16 v[32:47], v[16:19], v[80:83], v[32:47]
    v_mfma_f32_32x32x16_bf16 v[48:63], v[20:23], v[80:83], v[48:63]
    ds_read_b64_tr_b16 v[16:17], v4 offset:12288
    ds_read_b64_tr_b16 v[18:19], v4 offset:13312
    ds_read_b64_tr_b16 v[20:21], v15 offset:12288
    ds_read_b64_tr_b16 v[22:23], v15 offset:13312
    s_waitcnt lgkmcnt(4)
    v_mfma_f32_32x32x16_bf16 v[32:47], v[24:27], v[84:87], v[32:47]
    v_mfma_f32_32x32x16_bf16 v[48:63], v[28:31], v[84:87], v[48:63]
    ds_read_b64_tr_b16 v[24:25], v4 offset:14336
    ds_read_b64_tr_b16 v[26:27], v4 offset:15360
    ds_read_b64_tr_b16 v[28:29], v15 offset:14336
    ds_read_b64_tr_b16 v[30:31], v15 offset:15360
    s_waitcnt lgkmcnt(4)
    v_mfma_f32_32x32x16_bf16 v[32:47], v[16:19], v[88:91], v[32:47]
    v_mfma_f32_32x32x16_bf16 v[48:63], v[20:23], v[88:91], v[48:63]
    s_waitcnt lgkmcnt(0)
    v_mfma_f32_32x32x16_bf16 v[32:47], v[24:27], v[92:95], v[32:47]
    v_mfma_f32_32x32x16_bf16 v[48:63], v[28:31], v[92:95], v[48:63]
    s_waitcnt vmcnt(10)
    s_barrier
    ds_read_b64_tr_b16 v[16:17], v4 offset:16384
    ds_read_b64_tr_b16 v[18:19], v4 offset:17408
    ds_read_b64_tr_b16 v[20:21], v15 offset:16384
    ds_read_b64_tr_b16 v[22:23], v15 offset:17408
    ds_read_b64_tr_b16 v[24:25], v4 offset:18432
    ds_read_b64_tr_b16 v[26:27], v4 offset:19456
    ds_read_b64_tr_b16 v[28:29], v15 offset:18432
    ds_read_b64_tr_b16 v[30:31], v15 offset:19456
    s_waitcnt lgkmcnt(4)
    v_mfma_f32_32x32x16_bf16 v[32:47], v[16:19], v[96:99], v[32:47]
    v_mfma_f32_32x32x16_bf16 v[48:63], v[20:23], v[96:99], v[48:63]
    ds_read_b64_tr_b16 v[16:17], v4 offset:20480
    ds_read_b64_tr_b16 v[18:19], v4 offset:21504
    ds_read_b64_tr_b16 v[20:21], v15 offset:20480
    ds_read_b64_tr_b16 v[22:23], v15 offset:21504
    s_waitcnt lgkmcnt(4)
    v_mfma_f32_32x32x16_bf16 v[32:47], v[24:27], v[100:103], v[32:47]
    v_mfma_f32_32x32x16_bf16 v[48:63], v[28:31], v[100:103], v[48:63]
    ds_read_b64_tr_b16 v[24:25], v4 offset:22528
    ds_read_b64_tr_b16 v[26:27], v4 offset:23552
    ds_read_b64_tr_b16 v[28:29], v15 offset:22528
    ds_read_b64_tr_b16 v[30:31], v15 offset:23552
    s_waitcnt lgkmcnt(4)
    v_mfma_f32_32x32x16_bf16 v[32:47], v[16:19], v[104:107], v[32:47]
    v_mfma_f32_32x32x16_bf16 v[48:63], v[20:23], v[104:107], v[48:63]
    s_waitcnt lgkmcnt(0)
    v_mfma_f32_32x32x16_bf16 v[32:47], v[24:27], v[108:111], v[32:47]
    v_mfma_f32_32x32x16_bf16 v[48:63], v[28:31], v[108:111], v[48:63]
    s_waitcnt vmcnt(2)
    s_barrier
    ds_read_b64_tr_b16 v[16:17], v4 offset:24576
    ds_read_b64_tr_b16 v[18:19], v4 offset:25600
    ds_read_b64_tr_b16 v[20:21], v15 offset:24576
    ds_read_b64_tr_b16 v[22:23], v15 offset:25600
    ds_read_b64_tr_b16 v[24:25], v4 offset:26624
    ds_read_b64_tr_b16 v[26:27], v4 offset:27648
    ds_read_b64_tr_b16 v[28:29], v15 offset:26624
    ds_read_b64_tr_b16 v[30:31], v15 offset:27648
    s_waitcnt lgkmcnt(4)
    v_mfma_f32_32x32x16_bf16 v[32:47], v[16:19], v[112:115], v[32:47]
    v_mfma_f32_32x32x16_bf16 v[48:63], v[20:23], v[112:115], v[48:63]
    ds_read_b64_tr_b16 v[16:17], v4 offset:28672
    ds_read_b64_tr_b16 v[18:19], v4 offset:29696
    ds_read_b64_tr_b16 v[20:21], v15 offset:28672
    ds_read_b64_tr_b16 v[22:23], v15 offset:29696
    s_waitcnt lgkmcnt(4)
    v_mfma_f32_32x32x16_bf16 v[32:47], v[24:27], v[116:119], v[32:47]
    v_mfma_f32_32x32x16_bf16 v[48:63], v[28:31], v[116:119], v[48:63]
    ds_read_b64_tr_b16 v[24:25], v4 offset:30720
    ds_read_b64_tr_b16 v[26:27], v4 offset:31744
    ds_read_b64_tr_b16 v[28:29], v15 offset:30720
    ds_read_b64_tr_b16 v[30:31], v15 offset:31744
    s_waitcnt lgkmcnt(4)
    v_mfma_f32_32x32x16_bf16 v[32:47], v[16:19], v[120:123], v[32:47]
    v_mfma_f32_32x32x16_bf16 v[48:63], v[20:23], v[120:123], v[48:63]
    s_waitcnt lgkmcnt(0)
    v_mfma_f32_32x32x16_bf16 v[32:47], v[24:27], v[124:127], v[32:47]
    v_mfma_f32_32x32x16_bf16 v[48:63], v[28:31], v[124:127], v[48:63]
    s_waitcnt vmcnt(0)
    s_barrier
    s_nop 15
    v_xor_b32 v5, 0, v14
    ds_write_b128 v5, v[32:35] offset:0
    v_xor_b32 v5, 32, v14
    ds_write_b128 v5, v[36:39] offset:1024
    v_xor_b32 v5, 64, v14
    ds_write_b128 v5, v[40:43] offset:2048
    v_xor_b32 v5, 96, v14
    ds_write_b128 v5, v[44:47] offset:3072
    v_xor_b32 v5, 128, v14
    ds_write_b128 v5, v[48:51] offset:4096
    v_xor_b32 v5, 160, v14
    ds_write_b128 v5, v[52:55] offset:5120
    v_xor_b32 v5, 192, v14
    ds_write_b128 v5, v[56:59] offset:6144
    v_xor_b32 v5, 224, v14
    ds_write_b128 v5, v[60:63] offset:7168
    v_lshrrev_b32 v5, 3, v1
    s_lshl_b32 s35, s40, 3
    v_add_u32 v5, s35, v5
    v_and_b32 v6, 7, v1
    v_lshlrev_b32 v7, 1, v6
    v_xor_b32 v7, v7, v5
    v_lshlrev_b32 v7, 4, v7
    v_lshl_add_u32 v7, v6, 10, v7
    s_lshl_b32 s35, s31, 13
    v_add_u32 v14, s35, v7
    v_lshlrev_b32 v8, 10, v5
    v_lshl_add_u32 v8, v6, 4, v8
    s_lshl_b32 s34, s28, 1
    s_add_u32 s34, s34, s31
    s_lshl_b32 s34, s34, 15
    s_lshl_b32 s35, s29, 7
    s_add_u32 s34, s34, s35
    s_waitcnt lgkmcnt(0)
    s_barrier
    ds_read_b128 v[64:67], v14 offset:0
    ds_read_b128 v[68:71], v14 offset:512
    ds_read_b128 v[72:75], v14 offset:16384
    ds_read_b128 v[76:79], v14 offset:16896
    ds_read_b128 v[80:83], v14 offset:32768
    ds_read_b128 v[84:87], v14 offset:33280
    ds_read_b128 v[88:91], v14 offset:49152
    ds_read_b128 v[92:95], v14 offset:49664
    s_waitcnt lgkmcnt(0)
    v_add_f32 v64, v64, v72
    v_add_f32 v80, v80, v88
    v_cvt_pk_bf16_f32 v64, 0, v64
    v_cvt_pk_bf16_f32 v80, 0, v80
    v_mul_f32 v64, v12, v64
    v_mul_f32 v80, v13, v80
    v_cvt_pk_bf16_f32 v64, 0, v64
    v_cvt_pk_bf16_f32 v80, 0, v80
    v_add_f32 v64, v64, v80
    v_add_f32 v65, v65, v73
    v_add_f32 v81, v81, v89
    v_cvt_pk_bf16_f32 v65, 0, v65
    v_cvt_pk_bf16_f32 v81, 0, v81
    v_mul_f32 v65, v12, v65
    v_mul_f32 v81, v13, v81
    v_cvt_pk_bf16_f32 v65, 0, v65
    v_cvt_pk_bf16_f32 v81, 0, v81
    v_add_f32 v65, v65, v81
    v_add_f32 v66, v66, v74
    v_add_f32 v82, v82, v90
    v_cvt_pk_bf16_f32 v66, 0, v66
    v_cvt_pk_bf16_f32 v82, 0, v82
    v_mul_f32 v66, v12, v66
    v_mul_f32 v82, v13, v82
    v_cvt_pk_bf16_f32 v66, 0, v66
    v_cvt_pk_bf16_f32 v82, 0, v82
    v_add_f32 v66, v66, v82
    v_add_f32 v67, v67, v75
    v_add_f32 v83, v83, v91
    v_cvt_pk_bf16_f32 v67, 0, v67
    v_cvt_pk_bf16_f32 v83, 0, v83
    v_mul_f32 v67, v12, v67
    v_mul_f32 v83, v13, v83
    v_cvt_pk_bf16_f32 v67, 0, v67
    v_cvt_pk_bf16_f32 v83, 0, v83
    v_add_f32 v67, v67, v83
    v_add_f32 v68, v68, v76
    v_add_f32 v84, v84, v92
    v_cvt_pk_bf16_f32 v68, 0, v68
    v_cvt_pk_bf16_f32 v84, 0, v84
    v_mul_f32 v68, v12, v68
    v_mul_f32 v84, v13, v84
    v_cvt_pk_bf16_f32 v68, 0, v68
    v_cvt_pk_bf16_f32 v84, 0, v84
    v_add_f32 v68, v68, v84
    v_add_f32 v69, v69, v77
    v_add_f32 v85, v85, v93
    v_cvt_pk_bf16_f32 v69, 0, v69
    v_cvt_pk_bf16_f32 v85, 0, v85
    v_mul_f32 v69, v12, v69
    v_mul_f32 v85, v13, v85
    v_cvt_pk_bf16_f32 v69, 0, v69
    v_cvt_pk_bf16_f32 v85, 0, v85
    v_add_f32 v69, v69, v85
    v_add_f32 v70, v70, v78
    v_add_f32 v86, v86, v94
    v_cvt_pk_bf16_f32 v70, 0, v70
    v_cvt_pk_bf16_f32 v86, 0, v86
    v_mul_f32 v70, v12, v70
    v_mul_f32 v86, v13, v86
    v_cvt_pk_bf16_f32 v70, 0, v70
    v_cvt_pk_bf16_f32 v86, 0, v86
    v_add_f32 v70, v70, v86
    v_add_f32 v71, v71, v79
    v_add_f32 v87, v87, v95
    v_cvt_pk_bf16_f32 v71, 0, v71
    v_cvt_pk_bf16_f32 v87, 0, v87
    v_mul_f32 v71, v12, v71
    v_mul_f32 v87, v13, v87
    v_cvt_pk_bf16_f32 v71, 0, v71
    v_cvt_pk_bf16_f32 v87, 0, v87
    v_add_f32 v71, v71, v87
    v_cvt_pk_bf16_f32 v32, v64, v65
    v_cvt_pk_bf16_f32 v33, v66, v67
    v_cvt_pk_bf16_f32 v34, v68, v69
    v_cvt_pk_bf16_f32 v35, v70, v71
    buffer_store_dwordx4 v[32:35], v8, s[20:23], s34 offen
L_out_end:
    s_endpgm
.section .rodata,"a"
.p2align 6
.amdhsa_kernel proj_kernel
  .amdhsa_next_free_vgpr 212
  .amdhsa_next_free_sgpr 102
  .amdhsa_accum_offset 212
  .amdhsa_group_segment_fixed_size 0
  .amdhsa_kernarg_size 96
  .amdhsa_user_sgpr_count 2
  .amdhsa_user_sgpr_kernarg_segment_ptr 1
  .amdhsa_system_sgpr_workgroup_id_x 1
.end_amdhsa_kernel
.section .rodata,"a"
.p2align 6
.amdhsa_kernel attn_kernel
  .amdhsa_next_free_vgpr 112
  .amdhsa_next_free_sgpr 102
  .amdhsa_accum_offset 112
  .amdhsa_group_segment_fixed_size 0
  .amdhsa_kernarg_size 96
  .amdhsa_user_sgpr_count 2
  .amdhsa_user_sgpr_kernarg_segment_ptr 1
  .amdhsa_system_sgpr_workgroup_id_x 1
.end_amdhsa_kernel
.section .rodata,"a"
.p2align 6
.amdhsa_kernel out_kernel
  .amdhsa_next_free_vgpr 128
  .amdhsa_next_free_sgpr 102
  .amdhsa_accum_offset 128
  .amdhsa_group_segment_fixed_size 0
  .amdhsa_kernarg_size 96
  .amdhsa_user_sgpr_count 2
  .amdhsa_user_sgpr_kernarg_segment_ptr 1
  .amdhsa_system_sgpr_workgroup_id_x 1
.end_amdhsa_kernel
```
